```python
import torch

def _softmax(x, axis=-1):
    return torch.softmax(x, dim=axis)
def _gelu(x):
    return torch.nn.functional.gelu(x, approximate="tanh")
def _silu(x):
    return torch.nn.functional.silu(x)
def _sigmoid(x):
    return torch.sigmoid(x)
def _layernorm(x, axis=-1, eps=1e-5):
    m = x.mean(dim=axis, keepdim=True)
    v = x.var(dim=axis, keepdim=True, unbiased=False)
    return (x - m) / torch.sqrt(v + eps)
def _scatter_add(tgt, idx, src, axis=0):
    return tgt.clone().index_add_(axis, idx, src)
def _segment_sum(src, seg, n):
    out = torch.zeros((n,) + src.shape[1:], dtype=src.dtype)
    return out.index_add_(0, seg, src)
def _pad(x, pw):
    flat = tuple(v for pair in reversed(pw) for v in pair)
    return torch.nn.functional.pad(x, flat)

kernel_name = 'gated_mix__sliding_block_cached__dense_activation_relu__decode'

def setup_inputs():

    _w = (lambda a: (lambda t: t.to(torch.bfloat16) if t.is_floating_point() else t)(torch.as_tensor(a)))
    def _A_setup():
        B, Sq, D = 8, 1, 1024
        Hq, Hkv, Sk, Dh = 32, 4, 4096, 128
        assert Hq % Hkv == 0, (Hq, Hkv)
        return {
            "x": _w((lambda *s: torch.randn(*s, dtype=torch.bfloat16) * 0.05)(B, Sq, D)),
            "k_cache": _w((lambda *s: torch.randn(*s, dtype=torch.bfloat16) * 6.4)(B, Hkv, Sk, Dh)),
            "v_cache": _w((lambda *s: torch.randn(*s, dtype=torch.bfloat16) * 0.4)(B, Hkv, Sk, Dh)),
            "wq": _w((lambda *s: torch.randn(*s, dtype=torch.bfloat16) * 6.4)(D, Hq * Dh) * (D ** -0.5)),
            "wo": _w((lambda *s: torch.randn(*s, dtype=torch.bfloat16) * 0.4)(Hq * Dh, D) * ((Hq * Dh) ** -0.5)),
        }
    _A_in = _A_setup()

    def _B_setup():
        B, S, D, Dff = 8, 1, 1024, 3584
        return {
            "x": _w((lambda *s: torch.randn(*s, dtype=torch.bfloat16) * 0.05)(B, S, D)),
            "w1": _w((lambda *s: torch.randn(*s, dtype=torch.bfloat16) * 0.05)(D, Dff)),
            "w2": _w((lambda *s: torch.randn(*s, dtype=torch.bfloat16) * 0.05)(Dff, D)),
        }
    _B_in = _B_setup()

    return {
        "A_x": _A_in["x"],
        "A_k_cache": _A_in["k_cache"],
        "A_v_cache": _A_in["v_cache"],
        "A_wq": _A_in["wq"],
        "A_wo": _A_in["wo"],
        "B_x": _B_in["x"],
        "B_w1": _B_in["w1"],
        "B_w2": _B_in["w2"],
        "gate_w": _w((lambda *s: torch.randn(*s, dtype=torch.bfloat16) * 0.05)(1024) * 16.0),
    }

def reference(A_x, A_k_cache, A_v_cache, A_wq, A_wo, B_x, B_w1, B_w2, gate_w):
    def _A_ref(x, k_cache, v_cache, wq, wo):
        B, Sq, D = x.shape
        Hq, Dh = 32, 128
        Hkv, Sk = k_cache.shape[1], k_cache.shape[2]
        W = min(4096, max(256, Sk // 4))
        rep = Hq // Hkv
        q = (lambda x, *d: x.permute(*d))((x @ wq).reshape(B, Sq, Hq, Dh), 0, 2, 1, 3)
        k = (lambda x, n, axis: torch.repeat_interleave(x, n, dim=axis))(k_cache[:, :, Sk - W:, :], rep, axis=1)
        v = (lambda x, n, axis: torch.repeat_interleave(x, n, dim=axis))(v_cache[:, :, Sk - W:, :], rep, axis=1)
        scores = torch.einsum("bhqd,bhkd->bhqk", q, k) * (Dh ** -0.5)
        p = _softmax(scores, axis=-1)
        o = torch.einsum("bhqk,bhkd->bhqd", p, v)
        return (lambda x, *d: x.permute(*d))(o, 0, 2, 1, 3).reshape(B, Sq, Hq * Dh) @ wo

    def _B_ref(x, w1, w2):
        h = torch.einsum("bsd,df->bsf", x, w1)
        zero = torch.zeros_like(h)
        h = torch.maximum(h, zero)
        return torch.einsum("bsf,fd->bsd", h, w2)

    x = A_x
    g = _sigmoid((x * gate_w).sum(-1, keepdims=True))
    a = _A_ref(x, A_k_cache, A_v_cache, A_wq, A_wo)
    b = _B_ref(x, B_w1, B_w2)
    return g * a + (1 - g) * b
```

```asm
; @launch grid=(256,1,1) block=(576,1,1) lds=155648
.amdgcn_target "amdgcn-amd-amdhsa--gfx950"
.text
.globl gated_mix__sliding_block_cached__dense_activation_relu__decode_kernel
.p2align 8
.type gated_mix__sliding_block_cached__dense_activation_relu__decode_kernel,@function
gated_mix__sliding_block_cached__dense_activation_relu__decode_kernel:
    s_load_dwordx16 s[16:31], s[0:1], 0
    v_readfirstlane_b32 s3, v0
    s_cmp_ge_u32 s2, 256
    s_cbranch_scc1 L_exit
    s_lshr_b32 s4, s2, 6
    s_and_b32 s5, s2, 63
    s_lshr_b32 s3, s3, 6
    s_cbranch_scc1 L_stub
    v_lshrrev_b32 v13, 3, v0
    v_and_b32 v2, 6, v13
    v_and_b32 v3, 7, v0
    v_xor_b32 v3, v3, v2
    v_lshlrev_b32 v12, 4, v3
    v_lshl_add_u32 v5, v13, 13, v12
    s_lshl_b32 s10, s5, 7
    s_lshl_b32 s9, s4, 21
    s_add_u32 s9, s9, s10
    s_mov_b32 s50, 0x800000
    s_mov_b32 s51, 0x20000
    s_mov_b32 s11, 0xfc00
    s_mov_b32 m0, 0
    s_setprio 3
    s_waitcnt lgkmcnt(0)
    s_mov_b64 s[48:49], s[22:23]
L_burst:
    buffer_load_dwordx4 v5, s[48:51], s9 offen offset:0 nt lds
    s_add_u32 s9, s9, s11
    buffer_load_dwordx4 v5, s[48:51], s9 offen offset:1024 nt lds
    s_add_u32 s9, s9, s11
    buffer_load_dwordx4 v5, s[48:51], s9 offen offset:2048 nt lds
    s_add_u32 s9, s9, s11
    buffer_load_dwordx4 v5, s[48:51], s9 offen offset:3072 nt lds
    s_add_u32 s9, s9, s11
    s_addk_i32 s9, 0x1000
    s_add_u32 m0, m0, 0x1000
    s_bitcmp0_b32 m0, 15
    s_cbranch_scc1 L_burst
    s_branch L_loader
L_stub:
    s_load_dwordx8 s[32:39], s[0:1], 64
    s_getpc_b64 s[54:55]
L_pc:
    v_subrev_u32 v2, 64, v0
    v_lshlrev_b32 v2, 7, v2
    v_min_u32 v2, L_codeend-L_pc-4, v2
    global_load_dword v160, v2, s[54:55]
    v_and_b32 v1, 63, v0
    s_mov_b32 s41, 0
    s_and_b32 s6, s2, 7
    s_lshr_b32 s7, s2, 3
    v_mov_b32 v3, 0
    v_lshlrev_b32 v9, 2, v0
    v_add_u32 v9, 151552, v9
    v_lshlrev_b32 v2, 2, v1
    v_add_u32 v2, 151552, v2
    ds_write_b32 v9, v3
    ds_write_b32 v2, v3
    ds_write_b32 v2, v3 offset:2816
    v_lshrrev_b32 v3, 5, v0
    v_subrev_u32 v3, 2, v3
    v_and_b32 v2, 31, v1
    v_xor_b32 v2, v2, v3
    v_lshlrev_b32 v2, 4, v2
    v_lshl_add_u32 v2, v3, 11, v2
    s_lshl_b32 s8, s4, 9
    v_add_u32 v2, s8, v2
    s_lshl_b32 s8, s3, 10
    s_add_u32 m0, s8, 130048
    s_waitcnt lgkmcnt(0)
    s_load_dword s40, s[38:39], 0
    s_cmp_gt_u32 s3, 4
    s_cbranch_scc1 L_nx
    global_load_lds_dwordx4 v2, s[16:17]
L_nx:
    s_cmp_lg_u32 s3, 5
    s_cbranch_scc1 L_ng5
    s_and_b32 s8, s7, 7
    s_lshl_b32 s8, s8, 11
    v_lshlrev_b32 v2, 5, v1
    v_add_u32 v3, s8, v2
    global_load_dwordx4 v[96:99], v3, s[16:17]
    global_load_dwordx4 v[100:103], v3, s[16:17] offset:16
    global_load_dwordx4 v[104:107], v2, s[32:33]
    global_load_dwordx4 v[108:111], v2, s[32:33] offset:16
L_ng5:
    s_barrier
    s_waitcnt vmcnt(0) lgkmcnt(0)
    v_mov_b32 v2, 1
    ds_write_b32 v9, v2
    s_branch L_notloader
L_loader:
    v_mov_b32 v1, v0
    s_mov_b32 s41, 0
    s_and_b32 s6, s2, 7
    s_lshr_b32 s7, s2, 3
    v_lshrrev_b32 v14, 4, v1
    v_and_b32 v15, 15, v1
    v_xor_b32 v2, v15, v14
    v_lshlrev_b32 v2, 4, v2
    v_lshl_add_u32 v5, v14, 8, v2
    v_xor_b32 v6, 64, v5
    v_xor_b32 v7, 0x80, v5
    v_xor_b32 v8, 64, v7
    v_lshlrev_b32 v9, 1, v14
    v_xor_b32 v9, v15, v9
    v_lshlrev_b32 v9, 4, v9
    v_mov_b32 v29, 151552
    v_lshl_add_u32 v10, v1, 2, v29
    v_and_b32 v2, 3, v1
    v_mul_u32_u24 v2, 0x104, v2
    v_add_u32 v29, v2, v29
    s_mul_i32 s42, s4, 1835008
    s_add_u32 s42, s42, s10
    s_and_b32 s15, s7, 24
    s_add_u32 s15, s15, s6
    s_lshl_b32 s15, s15, 5
    s_and_b32 s12, s7, 7
    s_add_u32 s15, s15, s12
    s_add_u32 s15, s15, 24
    s_lshl_b32 s15, s15, 15
    s_lshl_b32 s14, s12, 12
    s_mov_b64 s[48:49], s[18:19]
    s_mov_b32 s50, 0x2000000
    s_mov_b32 s9, s15
    s_mov_b32 s13, 8
    s_mov_b32 s10, 32768
    s_mov_b32 s43, 16
    s_barrier
    s_call_b64 s[52:53], L_loopx
    v_lshl_add_u32 v5, v14, 8, v9
    v_xor_b32 v6, 0x80, v5
    v_mov_b32 v7, v5
    v_mov_b32 v8, v6
    s_mov_b64 s[48:49], s[20:21]
    s_mov_b32 s9, s15
    s_mov_b32 s13, 8
    s_call_b64 s[52:53], L_loopx
    s_cmp_eq_u32 s12, 7
    s_cbranch_scc1 L_now1
    v_mul_u32_u24 v5, 0x1c00, v13
    v_add_u32 v5, v5, v12
    v_mov_b32 v6, v5
    s_mov_b32 m0, 98304
    s_mov_b32 s50, 0x700000
    s_mov_b64 s[48:49], s[28:29]
    s_mov_b32 s9, s42
    s_mov_b32 s11, 56320
    s_mov_b32 s13, 8
    s_call_b64 s[52:53], L_loop
L_now1:
    v_lshl_add_u32 v5, v14, 11, v9
    v_xor_b32 v6, 0x80, v5
    s_mov_b64 s[48:49], s[24:25]
    s_mov_b32 s50, 0x800000
    s_lshl_b32 s9, s7, 10
    s_add_u32 s9, s9, s6
    s_lshl_b32 s9, s9, 8
    s_movk_i32 s11, 0x1c00
    s_mov_b32 s13, 8
    s_mov_b32 m0, 0
W_1:
    ds_read_b32 v2, v29 offset:256
    s_waitcnt lgkmcnt(0)
    v_cmp_gt_i32 vcc, 2, v2
    s_cbranch_vccz W_1d
    s_add_u32 s41, s41, 1
    s_cmp_lt_u32 s41, 400000
    s_cbranch_scc1 W_1
W_1d:
    s_cmp_eq_u32 s12, 7
    s_cbranch_scc0 L_wonorm
    s_add_i32 s43, s43, -12
    s_call_b64 s[52:53], L_loop3
    s_add_i32 s43, s43, 12
    s_branch L_now2
L_wonorm:
    s_call_b64 s[52:53], L_loop
    s_mov_b64 s[48:49], s[30:31]
    s_mov_b32 s50, 0x700000
    s_sub_u32 s9, s7, s4
    s_lshl_b32 s9, s9, 10
    s_add_u32 s9, s9, s6
    s_lshl_b32 s9, s9, 8
    s_mov_b32 s13, 8
W_2:
    ds_read_b32 v2, v29 offset:256
    s_waitcnt lgkmcnt(0)
    v_cmp_gt_i32 vcc, 3, v2
    s_cbranch_vccz W_2d
    s_add_u32 s41, s41, 1
    s_cmp_lt_u32 s41, 400000
    s_cbranch_scc1 W_2
W_2d:
    s_call_b64 s[52:53], L_loop
L_now2:
    s_waitcnt vmcnt(8)
    s_add_i32 s43, s43, 8
    v_mov_b32 v11, s43
    ds_write_b32 v10, v11
    s_waitcnt vmcnt(0)
    s_add_i32 s43, s43, 8
    v_mov_b32 v11, s43
    ds_write_b32 v10, v11
L_exit:
    s_endpgm
L_loopx:
    s_xor_b32 m0, s10, s14
    s_xor_b32 s8, s9, s14
    s_waitcnt vmcnt(19)
    buffer_load_dwordx4 v5, s[48:51], s8 offen offset:0 nt lds
    s_waitcnt vmcnt(19)
    buffer_load_dwordx4 v6, s[48:51], s8 offen offset:1024 nt lds
    s_waitcnt vmcnt(19)
    buffer_load_dwordx4 v7, s[48:51], s8 offen offset:2048 nt lds
    s_waitcnt vmcnt(19)
    v_mov_b32 v11, s43
    ds_write_b32 v10, v11
    buffer_load_dwordx4 v8, s[48:51], s8 offen offset:3072 nt lds
    s_addk_i32 s9, 0x1000
    s_addk_i32 s10, 0x1000
    s_add_i32 s43, s43, 4
    s_sub_u32 s13, s13, 1
    s_cmp_lg_u32 s13, 0
    s_cbranch_scc1 L_loopx
    s_setpc_b64 s[52:53]
L_loop:
    s_waitcnt vmcnt(19)
    buffer_load_dwordx4 v5, s[48:51], s9 offen offset:0 nt lds
    s_add_u32 s9, s9, s11
    s_waitcnt vmcnt(19)
    buffer_load_dwordx4 v6, s[48:51], s9 offen offset:1024 nt lds
    s_add_u32 s9, s9, s11
    s_waitcnt vmcnt(19)
    buffer_load_dwordx4 v5, s[48:51], s9 offen offset:2048 nt lds
    s_add_u32 s9, s9, s11
    s_waitcnt vmcnt(19)
    v_mov_b32 v11, s43
    ds_write_b32 v10, v11
    buffer_load_dwordx4 v6, s[48:51], s9 offen offset:3072 nt lds
    s_add_u32 s9, s9, s11
    s_addk_i32 s9, 0x1000
    s_add_u32 m0, m0, 0x1000
    s_add_i32 s43, s43, 4
    s_sub_u32 s13, s13, 1
    s_cmp_lg_u32 s13, 0
    s_cbranch_scc1 L_loop
    s_setpc_b64 s[52:53]
L_loop3:
    s_waitcnt vmcnt(31)
    buffer_load_dwordx4 v5, s[48:51], s9 offen offset:0 nt lds
    s_add_u32 s9, s9, s11
    s_waitcnt vmcnt(31)
    buffer_load_dwordx4 v6, s[48:51], s9 offen offset:1024 nt lds
    s_add_u32 s9, s9, s11
    s_waitcnt vmcnt(31)
    buffer_load_dwordx4 v5, s[48:51], s9 offen offset:2048 nt lds
    s_add_u32 s9, s9, s11
    s_waitcnt vmcnt(31)
    v_mov_b32 v11, s43
    ds_write_b32 v10, v11
    buffer_load_dwordx4 v6, s[48:51], s9 offen offset:3072 nt lds
    s_add_u32 s9, s9, s11
    s_addk_i32 s9, 0x1000
    s_add_u32 m0, m0, 0x1000
    s_add_i32 s43, s43, 4
    s_sub_u32 s13, s13, 1
    s_cmp_lg_u32 s13, 0
    s_cbranch_scc1 L_loop3
    s_setpc_b64 s[52:53]
L_notloader:
    s_mov_b32 s44, s38
    s_mov_b32 s45, s39
    s_mov_b32 s46, 0x280000
    s_mov_b32 s47, 0x20000
    s_add_u32 s40, s40, 0x9e3779b1
    v_mov_b32 v15, s40
    v_mov_b32 v21, s40
    v_mov_b32 v23, s40
    v_and_b32 v4, 15, v1
    v_lshrrev_b32 v5, 4, v1
    v_and_b32 v6, 7, v1
    v_lshlrev_b32 v29, 4, v1
    s_cmp_lg_u32 s3, 5
    s_cbranch_scc1 L_nogate
    v_mov_b32 v16, 0
    v_mov_b32 v17, 0
    v_lshlrev_b32 v18, 16, v96
    v_and_b32 v19, 0xffff0000, v96
    v_lshlrev_b32 v24, 16, v104
    v_and_b32 v25, 0xffff0000, v104
    v_mul_f32 v18, v18, v24
    v_mul_f32 v19, v19, v25
    v_cvt_pk_bf16_f32 v18, v18, v19
    v_and_b32 v19, 0xffff0000, v18
    v_lshlrev_b32 v18, 16, v18
    v_add_f32 v16, v16, v18
    v_add_f32 v17, v17, v19
    v_lshlrev_b32 v18, 16, v97
    v_and_b32 v19, 0xffff0000, v97
    v_lshlrev_b32 v24, 16, v105
    v_and_b32 v25, 0xffff0000, v105
    v_mul_f32 v18, v18, v24
    v_mul_f32 v19, v19, v25
    v_cvt_pk_bf16_f32 v18, v18, v19
    v_and_b32 v19, 0xffff0000, v18
    v_lshlrev_b32 v18, 16, v18
    v_add_f32 v16, v16, v18
    v_add_f32 v17, v17, v19
    v_lshlrev_b32 v18, 16, v98
    v_and_b32 v19, 0xffff0000, v98
    v_lshlrev_b32 v24, 16, v106
    v_and_b32 v25, 0xffff0000, v106
    v_mul_f32 v18, v18, v24
    v_mul_f32 v19, v19, v25
    v_cvt_pk_bf16_f32 v18, v18, v19
    v_and_b32 v19, 0xffff0000, v18
    v_lshlrev_b32 v18, 16, v18
    v_add_f32 v16, v16, v18
    v_add_f32 v17, v17, v19
    v_lshlrev_b32 v18, 16, v99
    v_and_b32 v19, 0xffff0000, v99
    v_lshlrev_b32 v24, 16, v107
    v_and_b32 v25, 0xffff0000, v107
    v_mul_f32 v18, v18, v24
    v_mul_f32 v19, v19, v25
    v_cvt_pk_bf16_f32 v18, v18, v19
    v_and_b32 v19, 0xffff0000, v18
    v_lshlrev_b32 v18, 16, v18
    v_add_f32 v16, v16, v18
    v_add_f32 v17, v17, v19
    v_lshlrev_b32 v18, 16, v100
    v_and_b32 v19, 0xffff0000, v100
    v_lshlrev_b32 v24, 16, v108
    v_and_b32 v25, 0xffff0000, v108
    v_mul_f32 v18, v18, v24
    v_mul_f32 v19, v19, v25
    v_cvt_pk_bf16_f32 v18, v18, v19
    v_and_b32 v19, 0xffff0000, v18
    v_lshlrev_b32 v18, 16, v18
    v_add_f32 v16, v16, v18
    v_add_f32 v17, v17, v19
    v_lshlrev_b32 v18, 16, v101
    v_and_b32 v19, 0xffff0000, v101
    v_lshlrev_b32 v24, 16, v109
    v_and_b32 v25, 0xffff0000, v109
    v_mul_f32 v18, v18, v24
    v_mul_f32 v19, v19, v25
    v_cvt_pk_bf16_f32 v18, v18, v19
    v_and_b32 v19, 0xffff0000, v18
    v_lshlrev_b32 v18, 16, v18
    v_add_f32 v16, v16, v18
    v_add_f32 v17, v17, v19
    v_lshlrev_b32 v18, 16, v102
    v_and_b32 v19, 0xffff0000, v102
    v_lshlrev_b32 v24, 16, v110
    v_and_b32 v25, 0xffff0000, v110
    v_mul_f32 v18, v18, v24
    v_mul_f32 v19, v19, v25
    v_cvt_pk_bf16_f32 v18, v18, v19
    v_and_b32 v19, 0xffff0000, v18
    v_lshlrev_b32 v18, 16, v18
    v_add_f32 v16, v16, v18
    v_add_f32 v17, v17, v19
    v_lshlrev_b32 v18, 16, v103
    v_and_b32 v19, 0xffff0000, v103
    v_lshlrev_b32 v24, 16, v111
    v_and_b32 v25, 0xffff0000, v111
    v_mul_f32 v18, v18, v24
    v_mul_f32 v19, v19, v25
    v_cvt_pk_bf16_f32 v18, v18, v19
    v_and_b32 v19, 0xffff0000, v18
    v_lshlrev_b32 v18, 16, v18
    v_add_f32 v16, v16, v18
    v_add_f32 v17, v17, v19
    v_add_f32 v16, v16, v17
    s_nop 1
    v_add_f32_dpp v16, v16, v16 row_ror:1 row_mask:0xf bank_mask:0xf
    s_nop 1
    v_add_f32_dpp v16, v16, v16 row_ror:2 row_mask:0xf bank_mask:0xf
    s_nop 1
    v_add_f32_dpp v16, v16, v16 row_ror:4 row_mask:0xf bank_mask:0xf
    s_nop 1
    v_add_f32_dpp v16, v16, v16 row_ror:8 row_mask:0xf bank_mask:0xf
    v_mov_b32 v17, v16
    s_nop 1
    v_permlane16_swap_b32 v16, v17
    v_add_f32 v16, v16, v17
    v_mov_b32 v17, v16
    s_nop 1
    v_permlane32_swap_b32 v16, v17
    v_add_f32 v16, v16, v17
    v_cvt_pk_bf16_f32 v16, v16, v16
    v_lshlrev_b32 v16, 16, v16
    v_mul_f32 v16, 0xbfb8aa3b, v16
    v_exp_f32 v16, v16
    s_nop 0
    v_add_f32 v16, 1.0, v16
    v_rcp_f32 v16, v16
    s_nop 0
    v_cvt_pk_bf16_f32 v16, v16, v16
    v_lshlrev_b32 v16, 16, v16
    v_sub_f32 v17, 1.0, v16
    v_cvt_pk_bf16_f32 v22, v16, v17
    s_getreg_b32 s8, hwreg(HW_REG_XCC_ID, 0, 4)
    v_mov_b32 v20, s8
    s_lshl_b32 s8, s6, 5
    s_add_u32 s8, s8, s7
    s_lshl_b32 s8, s8, 4
    s_add_u32 s8, s8, 4096
    s_mov_b64 exec, 1
    buffer_store_dwordx4 v[20:23], v29, s[44:47], s8 offen sc1
    s_mov_b64 exec, -1
L_nogate:
    v_mov_b32 v7, 151552
    v_and_b32 v2, 3, v1
    v_mul_u32_u24 v2, 0x104, v2
    v_add_u32 v8, 151808, v2
    v_mul_u32_u24 v2, 0x104, v6
    v_add_u32 v166, 151808, v2
    v_lshrrev_b32 v2, 1, v5
    v_xor_b32 v2, v2, v6
    v_lshlrev_b32 v2, 4, v2
    v_lshl_add_u32 v10, v6, 9, v2
    v_and_b32 v2, 1, v5
    v_lshl_add_u32 v10, v2, 3, v10
    v_add_u32 v10, 131072, v10
    v_lshrrev_b32 v11, 2, v1
    v_and_b32 v12, 3, v1
    v_lshlrev_b32 v12, 3, v12
    s_mov_b32 s48, 0x00ff00ff
    s_mov_b32 s49, 0x00ff00ff
    s_mov_b32 s50, 0xff00ff00
    s_mov_b32 s51, 0xff00ff00
    s_sub_u32 s9, s3, 1
    s_and_b32 s9, s9, 3
    s_and_b32 s10, s7, 24
    s_add_u32 s10, s10, s6
    s_lshr_b32 s11, s10, 2
    s_and_b32 s12, s10, 3
    s_and_b32 s13, s7, 7
    v_lshrrev_b32 v2, 1, v11
    v_and_b32 v2, 3, v2
    v_xor_b32 v2, s9, v2
    v_lshlrev_b32 v2, 5, v2
    v_lshl_add_u32 v13, v11, 7, v2
    v_add_u32 v13, v13, v12
    v_lshlrev_b32 v14, 14, v6
    v_lshl_add_u32 v14, v5, 4, v14
    s_lshl_b32 s52, s4, 17
    s_lshl_b32 s8, s5, 8
    s_add_u32 s52, s52, s8
    s_lshl_b32 s8, s9, 6
    s_add_u32 s52, s52, s8
    v_and_b32 v2, 7, v11
    v_lshlrev_b32 v2, 5, v2
    v_lshl_add_u32 v150, v11, 8, v2
    v_add_u32 v150, v150, v12
    s_lshl_b32 s8, s9, 6
    v_xor_b32 v150, s8, v150
    v_xor_b32 v151, 32, v150
    v_mul_u32_u24 v152, 544, v6
    v_lshl_add_u32 v152, v5, 4, v152
    v_add_u32 v152, 137728, v152
    v_and_b32 v3, 31, v1
    v_lshrrev_b32 v28, 5, v1
    v_lshrrev_b32 v2, 3, v3
    v_lshlrev_b32 v154, 6, v2
    v_lshl_add_u32 v154, v12, 1, v154
    v_bfe_u32 v2, v3, 2, 1
    v_lshl_add_u32 v154, v2, 3, v154
    v_mul_u32_u24 v2, 544, v28
    v_add_u32 v154, v154, v2
    s_mul_i32 s8, s9, 1088
    s_add_u32 s8, s8, 137728
    v_add_u32 v154, s8, v154
    s_lshl_b32 s8, s9, 10
    s_add_u32 s8, s8, 146432
    v_add_u32 v147, s8, v29
    s_lshl_b32 s62, s10, 15
    s_add_u32 s62, s62, 1572864
    s_lshl_b32 s63, s10, 9
    s_add_u32 s63, s63, 16384
    s_cmp_ge_u32 s3, 5
    s_cbranch_scc1 L_B
    s_add_u32 s52, s52, 524288
    v_xor_b32 v2, v5, v4
    v_lshlrev_b32 v2, 4, v2
    v_lshl_add_u32 v24, v4, 8, v2
    s_lshl_b32 s8, s9, 13
    s_add_u32 s8, s8, 32768
    v_add_u32 v24, s8, v24
    v_xor_b32 v25, 64, v24
    v_xor_b32 v26, 0x80, v24
    v_xor_b32 v27, 0xc0, v24
    s_lshr_b32 s14, s13, 1
    s_lshl_b32 s8, s14, 13
    s_add_u32 s8, s8, 65536
    v_add_u32 v148, s8, v150
    v_add_u32 v149, s8, v151
    s_xor_b32 s86, s14, s9
    s_lshl_b32 s14, s86, 3
    s_add_u32 s14, s14, 40
    s_lshl_b32 s56, s11, 14
    s_lshl_b32 s8, s12, 12
    s_add_u32 s56, s56, s8
    s_lshl_b32 s8, s9, 10
    s_add_u32 s56, s56, s8
    s_add_u32 s56, s56, 524288
    s_add_u32 s57, s56, 0x20000
    s_add_u32 s58, s56, 0x40000
    s_add_u32 s59, s56, 0x60000
    v_mul_u32_u24 v2, 288, v28
    v_lshl_add_u32 v30, v3, 3, v2
    s_mul_i32 s8, s9, 576
    s_add_u32 s8, s8, 135168
    v_add_u32 v30, s8, v30
    v_mul_u32_u24 v31, 288, v6
    v_lshl_add_u32 v31, v5, 4, v31
    v_add_u32 v31, 135168, v31
    v_add_u32 v106, 142336, v29
    s_lshl_b32 s8, s86, 10
    v_add_u32 v104, s8, v106
    v_lshlrev_b32 v107, 5, v6
    v_add_u32 v107, 150528, v107
    s_lshl_b32 s8, s86, 2
    v_add_u32 v105, s8, v107
    v_lshrrev_b32 v2, 3, v4
    v_lshlrev_b32 v108, 12, v6
    v_lshl_add_u32 v108, v5, 4, v108
    v_lshl_add_u32 v108, v2, 6, v108
    v_lshlrev_b32 v109, 6, v6
    s_lshl_b32 s8, s9, 1
    s_lshl_b32 s42, 3, s8
    s_mov_b32 s43, 0
    s_lshl_b32 s8, s13, 2
    s_add_u32 s8, s8, s9
    s_lshl_b32 s8, s8, 7
    s_add_u32 s60, s62, s8
    s_and_b32 s8, s13, 1
    s_lshl_b32 s8, s8, 5
    s_add_u32 s61, s63, s8
    s_lshr_b32 s8, s13, 1
    s_lshl_b32 s8, s8, 3
    s_add_u32 s61, s61, s8
    s_lshl_b32 s87, s7, 2
    s_add_u32 s87, s87, s9
    s_lshl_b32 s87, s87, 10
    s_add_u32 s87, s87, 262144
    s_and_b32 s8, s6, 3
    s_lshl_b32 s8, s8, 7
    s_add_u32 s8, s8, s87
    s_add_u32 s54, s38, s8
    s_addc_u32 s55, s39, 0
    s_mov_b32 s64, 0x3db504f3
    s_mov_b32 s65, 0x3fb8aa3b
    s_cmp_eq_u32 s13, 7
    s_movk_i32 s67, 160
    s_cselect_b32 s67, 0x80, s67
    s_movk_i32 s66, 192
    s_cselect_b32 s66, 0x80, s66
    v_mov_b32 v157, v15
    v_mov_b32 v159, v15
    v_mov_b32 v111, v15
    v_lshl_add_u32 v153, v6, 3, v7
    s_lshl_b32 s8, s13, 12
    s_add_u32 s84, s62, s8
    s_lshl_b32 s8, s9, 5
    s_add_u32 s84, s84, s8
    v_lshrrev_b32 v2, 1, v1
    v_lshlrev_b32 v144, 7, v2
    v_and_b32 v2, 1, v1
    v_lshl_add_u32 v144, v2, 4, v144
    v_lshlrev_b32 v145, 3, v2
    v_lshl_add_u32 v145, v5, 1, v145
    s_mov_b32 s88, s34
    s_mov_b32 s89, s35
    s_mov_b32 s90, 0x4000
    s_mov_b32 s91, 0x20000
    s_lshr_b32 s85, s7, 2
    s_lshl_b32 s85, s85, 11
    s_lshl_b32 s8, s6, 8
    s_add_u32 s85, s85, s8
    s_and_b32 s8, s7, 3
    s_lshl_b32 s8, s8, 6
    s_add_u32 s85, s85, s8
    s_lshl_b32 s8, s9, 4
    s_add_u32 s85, s85, s8
W_3:
    ds_read_b32 v2, v166
    s_waitcnt lgkmcnt(0)
    v_cmp_gt_i32 vcc, 1, v2
    s_cbranch_vccz W_3d
    s_add_u32 s41, s41, 1
    s_cmp_lt_u32 s41, 400000
    s_cbranch_scc1 W_3
W_3d:
    ds_read_b64 v[32:33], v10 offset:0
    ds_read_b64 v[40:41], v10 offset:128
    ds_read_b64 v[48:49], v10 offset:256
    ds_read_b64 v[56:57], v10 offset:384
    v_xor_b32 v3, 32, v10
    ds_read_b64 v[34:35], v3 offset:0
    ds_read_b64 v[42:43], v3 offset:128
    ds_read_b64 v[50:51], v3 offset:256
    ds_read_b64 v[58:59], v3 offset:384
    v_xor_b32 v3, 64, v10
    ds_read_b64 v[36:37], v3 offset:0
    ds_read_b64 v[44:45], v3 offset:128
    ds_read_b64 v[52:53], v3 offset:256
    ds_read_b64 v[60:61], v3 offset:384
    v_xor_b32 v3, 96, v10
    ds_read_b64 v[38:39], v3 offset:0
    ds_read_b64 v[46:47], v3 offset:128
    ds_read_b64 v[54:55], v3 offset:256
    ds_read_b64 v[62:63], v3 offset:384
W_4:
    ds_read_b32 v2, v7
    s_waitcnt lgkmcnt(0)
    v_cmp_gt_i32 vcc, 24, v2
    s_cbranch_vccz W_4d
    s_add_u32 s41, s41, 1
    s_cmp_lt_u32 s41, 400000
    s_cbranch_scc1 W_4
W_4d:
    ds_read_b64_tr_b16 v[64:65], v13 offset:0
    ds_read_b64_tr_b16 v[66:67], v13 offset:2048
    ds_read_b64_tr_b16 v[68:69], v13 offset:4096
    ds_read_b64_tr_b16 v[70:71], v13 offset:6144
    ds_read_b64_tr_b16 v[72:73], v13 offset:8192
    ds_read_b64_tr_b16 v[74:75], v13 offset:10240
    ds_read_b64_tr_b16 v[76:77], v13 offset:12288
    ds_read_b64_tr_b16 v[78:79], v13 offset:14336
    ds_read_b64_tr_b16 v[80:81], v13 offset:16384
    ds_read_b64_tr_b16 v[82:83], v13 offset:18432
    ds_read_b64_tr_b16 v[84:85], v13 offset:20480
    ds_read_b64_tr_b16 v[86:87], v13 offset:22528
    s_waitcnt lgkmcnt(10)
    v_mfma_f32_16x16x32_bf16 v[16:19], v[64:67], v[32:35], 0
    s_waitcnt lgkmcnt(8)
    v_mfma_f32_16x16x32_bf16 v[16:19], v[68:71], v[36:39], v[16:19]
    s_waitcnt lgkmcnt(6)
    v_mfma_f32_16x16x32_bf16 v[16:19], v[72:75], v[40:43], v[16:19]
    s_waitcnt lgkmcnt(4)
    v_mfma_f32_16x16x32_bf16 v[16:19], v[76:79], v[44:47], v[16:19]
    s_waitcnt lgkmcnt(2)
    v_mfma_f32_16x16x32_bf16 v[16:19], v[80:83], v[48:51], v[16:19]
    s_waitcnt lgkmcnt(0)
    v_mfma_f32_16x16x32_bf16 v[16:19], v[84:87], v[52:55], v[16:19]
WR_5:
    ds_read_b32 v2, v7
    ds_read_b64_tr_b16 v[88:89], v13 offset:24576
    ds_read_b64_tr_b16 v[90:91], v13 offset:26624
    ds_read_b64_tr_b16 v[92:93], v13 offset:28672
    ds_read_b64_tr_b16 v[94:95], v13 offset:30720
    s_waitcnt lgkmcnt(4)
    v_cmp_gt_i32 vcc, 32, v2
    s_cbranch_vccz WR_5d
    s_add_u32 s41, s41, 1
    s_cmp_lt_u32 s41, 400000
    s_cbranch_scc1 WR_5
WR_5d:
    s_waitcnt lgkmcnt(2)
    v_mfma_f32_16x16x32_bf16 v[16:19], v[88:91], v[56:59], v[16:19]
    s_waitcnt lgkmcnt(0)
    v_mfma_f32_16x16x32_bf16 v[16:19], v[92:95], v[60:63], v[16:19]
    s_nop 7
    v_cvt_pk_bf16_f32 v20, v16, v17
    v_cvt_pk_bf16_f32 v22, v18, v19
    s_mov_b64 exec, s[48:49]
    buffer_store_dwordx4 v[20:23], v14, s[44:47], s52 offen sc1
    s_mov_b64 exec, -1
    v_mov_b32 v2, 2
    ds_write_b32 v9, v2
    v_xor_b32 v90, 0x2000, v148
    v_xor_b32 v91, 0x2000, v149
    v_xor_b32 v92, 0x4000, v148
    v_xor_b32 v93, 0x4000, v149
    v_xor_b32 v94, 0x6000, v148
    v_xor_b32 v95, 0x6000, v149
W_6:
    ds_read_b32 v2, v7
    s_waitcnt lgkmcnt(0)
    v_cmp_gt_i32 vcc, 64, v2
    s_cbranch_vccz W_6d
    s_add_u32 s41, s41, 1
    s_cmp_lt_u32 s41, 400000
    s_cbranch_scc1 W_6
W_6d:
    buffer_load_dwordx4 v[64:67], v29, s[44:47], s56 offen sc1
    buffer_load_dwordx4 v[68:71], v29, s[44:47], s57 offen sc1
    buffer_load_dwordx4 v[72:75], v29, s[44:47], s58 offen sc1
    buffer_load_dwordx4 v[76:79], v29, s[44:47], s59 offen sc1
W_8:
    ds_read_b32 v2, v7
    s_waitcnt lgkmcnt(0)
    v_cmp_gt_i32 vcc, s14, v2
    s_cbranch_vccz W_8d
    s_add_u32 s41, s41, 1
    s_cmp_lt_u32 s41, 400000
    s_cbranch_scc1 W_8
W_8d:
    ds_read_b128 v[32:35], v24 offset:0
    ds_read_b128 v[36:39], v25 offset:0
    ds_read_b128 v[40:43], v26 offset:0
    ds_read_b128 v[44:47], v27 offset:0
    ds_read_b128 v[48:51], v24 offset:4096
    ds_read_b128 v[52:55], v25 offset:4096
    ds_read_b128 v[56:59], v26 offset:4096
    ds_read_b128 v[60:63], v27 offset:4096
    s_waitcnt lgkmcnt(0)
    v_mov_b32 v2, 3
    ds_write_b32 v9, v2
G_7c:
    s_waitcnt vmcnt(0)
    v_xor_b32 v112, v65, v15
    v_bitop3_b32 v112, v112, v67, v15 bitop3:0xf6
    v_xor_b32 v113, v69, v15
    v_bitop3_b32 v113, v113, v71, v15 bitop3:0xf6
    v_xor_b32 v114, v73, v15
    v_bitop3_b32 v114, v114, v75, v15 bitop3:0xf6
    v_xor_b32 v115, v77, v15
    v_bitop3_b32 v115, v115, v79, v15 bitop3:0xf6
    v_or_b32 v2, v112, v113
    v_or3_b32 v2, v2, v114, v115
    v_cmp_ne_u32 vcc, 0, v2
    s_cbranch_vccz G_7d
    s_add_u32 s41, s41, 16
    s_cmp_ge_u32 s41, 400000
    s_cbranch_scc1 G_7d
    v_cmp_ne_u32 s[16:17], 0, v112
    v_cmp_ne_u32 s[18:19], 0, v113
    v_cmp_ne_u32 s[20:21], 0, v114
    v_cmp_ne_u32 s[22:23], 0, v115
    s_mov_b64 exec, s[16:17]
    s_cbranch_execz S_9
    buffer_load_dwordx4 v[64:67], v29, s[44:47], s56 offen sc1
S_9:
    s_mov_b64 exec, s[18:19]
    s_cbranch_execz S_10
    buffer_load_dwordx4 v[68:71], v29, s[44:47], s57 offen sc1
S_10:
    s_mov_b64 exec, s[20:21]
    s_cbranch_execz S_11
    buffer_load_dwordx4 v[72:75], v29, s[44:47], s58 offen sc1
S_11:
    s_mov_b64 exec, s[22:23]
    s_cbranch_execz S_12
    buffer_load_dwordx4 v[76:79], v29, s[44:47], s59 offen sc1
S_12:
    s_mov_b64 exec, -1
    s_branch G_7c
G_7d:
    v_lshlrev_b32 v16, 16, v64
    v_and_b32 v17, 0xffff0000, v64
    v_lshlrev_b32 v2, 16, v68
    v_and_b32 v3, 0xffff0000, v68
    v_add_f32 v16, v16, v2
    v_add_f32 v17, v17, v3
    v_lshlrev_b32 v2, 16, v72
    v_and_b32 v3, 0xffff0000, v72
    v_add_f32 v16, v16, v2
    v_add_f32 v17, v17, v3
    v_lshlrev_b32 v2, 16, v76
    v_and_b32 v3, 0xffff0000, v76
    v_add_f32 v16, v16, v2
    v_add_f32 v17, v17, v3
    v_lshlrev_b32 v18, 16, v66
    v_and_b32 v19, 0xffff0000, v66
    v_lshlrev_b32 v2, 16, v70
    v_and_b32 v3, 0xffff0000, v70
    v_add_f32 v18, v18, v2
    v_add_f32 v19, v19, v3
    v_lshlrev_b32 v2, 16, v74
    v_and_b32 v3, 0xffff0000, v74
    v_add_f32 v18, v18, v2
    v_add_f32 v19, v19, v3
    v_lshlrev_b32 v2, 16, v78
    v_and_b32 v3, 0xffff0000, v78
    v_add_f32 v18, v18, v2
    v_add_f32 v19, v19, v3
    v_cvt_pk_bf16_f32 v20, v16, v17
    v_cvt_pk_bf16_f32 v21, v18, v19
    ds_write_b64 v30, v[20:21]
    v_mov_b32 v2, 4
    ds_write_b32 v9, v2
WR_13:
    ds_read_b32 v2, v8
    ds_read_b128 v[64:67], v31 offset:0
    ds_read_b128 v[68:71], v31 offset:64
    ds_read_b128 v[72:75], v31 offset:128
    ds_read_b128 v[76:79], v31 offset:192
    s_waitcnt lgkmcnt(4)
    v_cmp_gt_i32 vcc, 4, v2
    s_cbranch_vccz WR_13d
    s_add_u32 s41, s41, 1
    s_cmp_lt_u32 s41, 400000
    s_cbranch_scc1 WR_13
WR_13d:
    s_waitcnt lgkmcnt(3)
    v_mfma_f32_16x16x32_bf16 v[16:19], v[32:35], v[64:67], 0
    v_mfma_f32_16x16x32_bf16 v[20:23], v[48:51], v[64:67], 0
    s_waitcnt lgkmcnt(2)
    v_mfma_f32_16x16x32_bf16 v[16:19], v[36:39], v[68:71], v[16:19]
    v_mfma_f32_16x16x32_bf16 v[20:23], v[52:55], v[68:71], v[20:23]
    s_waitcnt lgkmcnt(1)
    v_mfma_f32_16x16x32_bf16 v[16:19], v[40:43], v[72:75], v[16:19]
    v_mfma_f32_16x16x32_bf16 v[20:23], v[56:59], v[72:75], v[20:23]
    s_waitcnt lgkmcnt(0)
    v_mfma_f32_16x16x32_bf16 v[16:19], v[44:47], v[76:79], v[16:19]
    v_mfma_f32_16x16x32_bf16 v[20:23], v[60:63], v[76:79], v[20:23]
    s_nop 6
    v_cvt_pk_bf16_f32 v2, v16, v17
    v_lshlrev_b32 v16, 16, v2
    v_and_b32 v17, 0xffff0000, v2
    v_mul_f32 v16, s64, v16
    v_mul_f32 v17, s64, v17
    v_cvt_pk_bf16_f32 v2, v16, v17
    v_lshlrev_b32 v16, 16, v2
    v_and_b32 v17, 0xffff0000, v2
    v_cvt_pk_bf16_f32 v2, v18, v19
    v_lshlrev_b32 v18, 16, v2
    v_and_b32 v19, 0xffff0000, v2
    v_mul_f32 v18, s64, v18
    v_mul_f32 v19, s64, v19
    v_cvt_pk_bf16_f32 v2, v18, v19
    v_lshlrev_b32 v18, 16, v2
    v_and_b32 v19, 0xffff0000, v2
    v_cvt_pk_bf16_f32 v2, v20, v21
    v_lshlrev_b32 v20, 16, v2
    v_and_b32 v21, 0xffff0000, v2
    v_mul_f32 v20, s64, v20
    v_mul_f32 v21, s64, v21
    v_cvt_pk_bf16_f32 v2, v20, v21
    v_lshlrev_b32 v20, 16, v2
    v_and_b32 v21, 0xffff0000, v2
    v_cvt_pk_bf16_f32 v2, v22, v23
    v_lshlrev_b32 v22, 16, v2
    v_and_b32 v23, 0xffff0000, v2
    v_mul_f32 v22, s64, v22
    v_mul_f32 v23, s64, v23
    v_cvt_pk_bf16_f32 v2, v22, v23
    v_lshlrev_b32 v22, 16, v2
    v_and_b32 v23, 0xffff0000, v2
    v_max3_f32 v2, v16, v17, v18
    v_max3_f32 v3, v19, v20, v21
    v_max3_f32 v2, v2, v22, v23
    v_max_f32 v2, v2, v3
    v_mov_b32 v3, v2
    s_nop 1
    v_permlane16_swap_b32 v2, v3
    v_max_f32 v2, v2, v3
    v_mov_b32 v3, v2
    s_nop 1
    v_permlane32_swap_b32 v2, v3
    v_max_f32 v2, v2, v3
    v_mul_f32 v96, s65, v2
    v_fma_f32 v16, v16, s65, -v96
    v_fma_f32 v17, v17, s65, -v96
    v_fma_f32 v18, v18, s65, -v96
    v_fma_f32 v19, v19, s65, -v96
    v_fma_f32 v20, v20, s65, -v96
    v_fma_f32 v21, v21, s65, -v96
    v_fma_f32 v22, v22, s65, -v96
    v_fma_f32 v23, v23, s65, -v96
    v_exp_f32 v16, v16
    v_exp_f32 v17, v17
    v_exp_f32 v18, v18
    v_exp_f32 v19, v19
    v_exp_f32 v20, v20
    v_exp_f32 v21, v21
    v_exp_f32 v22, v22
    v_exp_f32 v23, v23
    v_cvt_pk_bf16_f32 v100, v16, v17
    v_cvt_pk_bf16_f32 v101, v18, v19
    v_cvt_pk_bf16_f32 v102, v20, v21
    v_cvt_pk_bf16_f32 v103, v22, v23
    ds_write_b128 v104, v[100:103]
    ds_read_b32 v28, v7
    ds_read_b32 v155, v7 offset:2816
    ds_read_b64 v[164:165], v153 offset:2560
    v_add_f32 v2, v16, v17
    v_add_f32 v3, v18, v19
    v_add_f32 v2, v2, v20
    v_add_f32 v3, v3, v21
    v_add_f32 v2, v2, v22
    v_add_f32 v3, v3, v23
    v_add_f32 v97, v2, v3
    v_mov_b32 v3, v97
    s_nop 1
    v_permlane16_swap_b32 v97, v3
    v_add_f32 v97, v97, v3
    v_mov_b32 v3, v97
    s_nop 1
    v_permlane32_swap_b32 v97, v3
    v_add_f32 v97, v97, v3
    s_mov_b64 exec, 0xff
    ds_write2_b32 v105, v96, v97 offset0:0 offset1:4
    s_mov_b64 exec, -1
    v_mov_b32 v2, 5
    ds_write_b32 v9, v2
    s_waitcnt lgkmcnt(2)
    v_cmp_gt_i32 vcc, 88, v28
    s_cbranch_vccnz L_vlate
    ds_read_b64_tr_b16 v[112:113], v148
    ds_read_b64_tr_b16 v[114:115], v148 offset:4096
    ds_read_b64_tr_b16 v[116:117], v149
    ds_read_b64_tr_b16 v[118:119], v149 offset:4096
    ds_read_b64_tr_b16 v[120:121], v90
    ds_read_b64_tr_b16 v[122:123], v90 offset:4096
    ds_read_b64_tr_b16 v[124:125], v91
    ds_read_b64_tr_b16 v[126:127], v91 offset:4096
    ds_read_b64_tr_b16 v[128:129], v92
    ds_read_b64_tr_b16 v[130:131], v92 offset:4096
    ds_read_b64_tr_b16 v[132:133], v93
    ds_read_b64_tr_b16 v[134:135], v93 offset:4096
WR_14:
    ds_read_b32 v2, v8
    ds_read_b128 v[64:67], v106 offset:0
    ds_read_b128 v[68:71], v106 offset:1024
    ds_read_b128 v[72:75], v106 offset:2048
    ds_read_b128 v[76:79], v106 offset:3072
    ds_read_b128 v[16:19], v107
    ds_read_b128 v[20:23], v107 offset:16
    s_waitcnt lgkmcnt(6)
    v_cmp_gt_i32 vcc, 5, v2
    s_cbranch_vccz WR_14d
    s_add_u32 s41, s41, 1
    s_cmp_lt_u32 s41, 400000
    s_cbranch_scc1 WR_14
WR_14d:
    s_waitcnt lgkmcnt(5)
    v_mfma_f32_16x16x32_bf16 v[32:35], v[112:115], v[64:67], 0
    v_mfma_f32_16x16x32_bf16 v[36:39], v[116:119], v[64:67], 0
    s_waitcnt lgkmcnt(4)
    v_mfma_f32_16x16x32_bf16 v[40:43], v[120:123], v[68:71], 0
    v_mfma_f32_16x16x32_bf16 v[44:47], v[124:127], v[68:71], 0
    s_waitcnt lgkmcnt(3)
    v_mfma_f32_16x16x32_bf16 v[48:51], v[128:131], v[72:75], 0
    v_mfma_f32_16x16x32_bf16 v[52:55], v[132:135], v[72:75], 0
    s_waitcnt lgkmcnt(0)
    ds_read_b32 v28, v7
    v_max3_f32 v98, v16, v17, v18
    v_max_f32 v98, v98, v19
    v_sub_f32 v16, v16, v98
    v_sub_f32 v17, v17, v98
    v_sub_f32 v18, v18, v98
    v_sub_f32 v19, v19, v98
    v_exp_f32 v16, v16
    v_exp_f32 v17, v17
    v_exp_f32 v18, v18
    v_exp_f32 v19, v19
    v_mul_f32 v3, v16, v20
    v_fmac_f32 v3, v17, v21
    v_fmac_f32 v3, v18, v22
    v_fmac_f32 v3, v19, v23
    v_rcp_f32 v20, v3
    v_log_f32 v21, v3
    v_mul_f32 v16, v16, v20
    v_mul_f32 v17, v17, v20
    v_mul_f32 v18, v18, v20
    v_mul_f32 v19, v19, v20
    v_add_f32 v110, v98, v21
    s_branch L_vdone
L_vlate:
WR_15:
    ds_read_b32 v2, v8
    ds_read_b128 v[64:67], v106 offset:0
    ds_read_b128 v[68:71], v106 offset:1024
    ds_read_b128 v[72:75], v106 offset:2048
    ds_read_b128 v[76:79], v106 offset:3072
    ds_read_b128 v[16:19], v107
    ds_read_b128 v[20:23], v107 offset:16
    s_waitcnt lgkmcnt(6)
    v_cmp_gt_i32 vcc, 5, v2
    s_cbranch_vccz WR_15d
    s_add_u32 s41, s41, 1
    s_cmp_lt_u32 s41, 400000
    s_cbranch_scc1 WR_15
WR_15d:
    s_waitcnt lgkmcnt(0)
    v_max3_f32 v98, v16, v17, v18
    v_max_f32 v98, v98, v19
    v_sub_f32 v16, v16, v98
    v_sub_f32 v17, v17, v98
    v_sub_f32 v18, v18, v98
    v_sub_f32 v19, v19, v98
    v_exp_f32 v16, v16
    v_exp_f32 v17, v17
    v_exp_f32 v18, v18
    v_exp_f32 v19, v19
    v_mul_f32 v3, v16, v20
    v_fmac_f32 v3, v17, v21
    v_fmac_f32 v3, v18, v22
    v_fmac_f32 v3, v19, v23
    v_rcp_f32 v20, v3
    v_log_f32 v21, v3
    v_mul_f32 v16, v16, v20
    v_mul_f32 v17, v17, v20
    v_mul_f32 v18, v18, v20
    v_mul_f32 v19, v19, v20
    v_add_f32 v110, v98, v21
W_16:
    ds_read_b32 v2, v7
    s_waitcnt lgkmcnt(0)
    v_cmp_gt_i32 vcc, 88, v2
    s_cbranch_vccz W_16d
    s_add_u32 s41, s41, 1
    s_cmp_lt_u32 s41, 400000
    s_cbranch_scc1 W_16
W_16d:
    ds_read_b64_tr_b16 v[112:113], v148
    ds_read_b64_tr_b16 v[114:115], v148 offset:4096
    ds_read_b64_tr_b16 v[116:117], v149
    ds_read_b64_tr_b16 v[118:119], v149 offset:4096
    ds_read_b64_tr_b16 v[120:121], v90
    ds_read_b64_tr_b16 v[122:123], v90 offset:4096
    ds_read_b64_tr_b16 v[124:125], v91
    ds_read_b64_tr_b16 v[126:127], v91 offset:4096
    ds_read_b64_tr_b16 v[128:129], v92
    ds_read_b64_tr_b16 v[130:131], v92 offset:4096
    ds_read_b64_tr_b16 v[132:133], v93
    ds_read_b64_tr_b16 v[134:135], v93 offset:4096
    s_waitcnt lgkmcnt(10)
    v_mfma_f32_16x16x32_bf16 v[32:35], v[112:115], v[64:67], 0
    s_waitcnt lgkmcnt(8)
    v_mfma_f32_16x16x32_bf16 v[36:39], v[116:119], v[64:67], 0
    s_waitcnt lgkmcnt(6)
    v_mfma_f32_16x16x32_bf16 v[40:43], v[120:123], v[68:71], 0
    s_waitcnt lgkmcnt(4)
    v_mfma_f32_16x16x32_bf16 v[44:47], v[124:127], v[68:71], 0
    s_waitcnt lgkmcnt(2)
    v_mfma_f32_16x16x32_bf16 v[48:51], v[128:131], v[72:75], 0
    s_waitcnt lgkmcnt(0)
    v_mfma_f32_16x16x32_bf16 v[52:55], v[132:135], v[72:75], 0
    ds_read_b32 v28, v7
L_vdone:
    s_waitcnt lgkmcnt(0)
    v_cmp_gt_i32 vcc, 96, v28
    s_cbranch_vccnz L_v3late
    ds_read_b64_tr_b16 v[136:137], v94
    ds_read_b64_tr_b16 v[138:139], v94 offset:4096
    ds_read_b64_tr_b16 v[140:141], v95
    ds_read_b64_tr_b16 v[142:143], v95 offset:4096
    v_mul_f32 v80, v16, v32
    v_mul_f32 v81, v16, v33
    v_mul_f32 v82, v16, v34
    v_mul_f32 v83, v16, v35
    v_mul_f32 v84, v16, v36
    v_mul_f32 v85, v16, v37
    v_mul_f32 v86, v16, v38
    v_mul_f32 v87, v16, v39
    v_fmac_f32 v80, v17, v40
    v_fmac_f32 v81, v17, v41
    v_fmac_f32 v82, v17, v42
    v_fmac_f32 v83, v17, v43
    v_fmac_f32 v84, v17, v44
    v_fmac_f32 v85, v17, v45
    v_fmac_f32 v86, v17, v46
    v_fmac_f32 v87, v17, v47
    v_fmac_f32 v80, v18, v48
    v_fmac_f32 v81, v18, v49
    v_fmac_f32 v82, v18, v50
    v_fmac_f32 v83, v18, v51
    v_fmac_f32 v84, v18, v52
    v_fmac_f32 v85, v18, v53
    v_fmac_f32 v86, v18, v54
    v_fmac_f32 v87, v18, v55
    s_branch L_v3done
L_v3late:
    s_nop 3
    v_mul_f32 v80, v16, v32
    v_mul_f32 v81, v16, v33
    v_mul_f32 v82, v16, v34
    v_mul_f32 v83, v16, v35
    v_mul_f32 v84, v16, v36
    v_mul_f32 v85, v16, v37
    v_mul_f32 v86, v16, v38
    v_mul_f32 v87, v16, v39
    v_fmac_f32 v80, v17, v40
    v_fmac_f32 v81, v17, v41
    v_fmac_f32 v82, v17, v42
    v_fmac_f32 v83, v17, v43
    v_fmac_f32 v84, v17, v44
    v_fmac_f32 v85, v17, v45
    v_fmac_f32 v86, v17, v46
    v_fmac_f32 v87, v17, v47
    v_fmac_f32 v80, v18, v48
    v_fmac_f32 v81, v18, v49
    v_fmac_f32 v82, v18, v50
    v_fmac_f32 v83, v18, v51
    v_fmac_f32 v84, v18, v52
    v_fmac_f32 v85, v18, v53
    v_fmac_f32 v86, v18, v54
    v_fmac_f32 v87, v18, v55
WR_17:
    ds_read_b32 v2, v7
    ds_read_b64_tr_b16 v[136:137], v94
    ds_read_b64_tr_b16 v[138:139], v94 offset:4096
    ds_read_b64_tr_b16 v[140:141], v95
    ds_read_b64_tr_b16 v[142:143], v95 offset:4096
    s_waitcnt lgkmcnt(4)
    v_cmp_gt_i32 vcc, 96, v2
    s_cbranch_vccz WR_17d
    s_add_u32 s41, s41, 1
    s_cmp_lt_u32 s41, 400000
    s_cbranch_scc1 WR_17
WR_17d:
L_v3done:
    v_readfirstlane_b32 s53, v155
    s_waitcnt lgkmcnt(2)
    v_mfma_f32_16x16x32_bf16 v[56:59], v[136:139], v[76:79], 0
    s_waitcnt lgkmcnt(0)
    v_mfma_f32_16x16x32_bf16 v[60:63], v[140:143], v[76:79], 0
    s_nop 5
    v_fmac_f32 v80, v19, v56
    v_fmac_f32 v81, v19, v57
    v_fmac_f32 v82, v19, v58
    v_fmac_f32 v83, v19, v59
    v_fmac_f32 v84, v19, v60
    v_fmac_f32 v85, v19, v61
    v_fmac_f32 v86, v19, v62
    v_fmac_f32 v87, v19, v63
    v_cvt_pk_bf16_f32 v16, v80, v81
    v_cvt_pk_bf16_f32 v17, v82, v83
    v_cvt_pk_bf16_f32 v18, v84, v85
    v_cvt_pk_bf16_f32 v19, v86, v87
    v_cndmask_b32 v156, v16, v18, s[50:51]
    v_cndmask_b32 v158, v17, v19, s[50:51]
    s_cmp_lg_u32 s53, 0
    s_cbranch_scc1 L_mok
W_18:
    ds_read_b32 v2, v7 offset:2816
    s_waitcnt lgkmcnt(0)
    v_cmp_gt_i32 vcc, 1, v2
    s_cbranch_vccz W_18d
    s_add_u32 s41, s41, 1
    s_cmp_lt_u32 s41, 400000
    s_cbranch_scc1 W_18
W_18d:
    v_readfirstlane_b32 s53, v2
    v_lshl_add_u32 v3, v6, 3, v7
    ds_read_b64 v[164:165], v3 offset:2560
L_mok:
    s_cmp_eq_u32 s53, 2
    s_cbranch_scc0 F_19
    buffer_store_dwordx4 v[156:159], v108, s[44:47], s60 offen
    s_mov_b64 exec, s[42:43]
    buffer_store_dwordx2 v[110:111], v109, s[44:47], s61 offen
    s_branch F_19e
F_19:
    buffer_store_dwordx4 v[156:159], v108, s[44:47], s60 offen sc1
    s_mov_b64 exec, s[42:43]
    buffer_store_dwordx2 v[110:111], v109, s[44:47], s61 offen sc1
F_19e:
    s_mov_b64 exec, -1
    v_mov_b32 v2, 6
    ds_write_b32 v9, v2
    s_cmp_lg_u32 s13, 7
    s_cbranch_scc1 L_nocomb
    s_mov_b32 s86, s9
    s_call_b64 s[94:95], L_comb
L_nocomb:
P_20:
    s_load_dword s16, s[54:55], 4 glc
    s_load_dword s17, s[54:55], 516 glc
    s_waitcnt lgkmcnt(0)
    s_cmp_eq_u32 s16, s40
    s_cbranch_scc0 P_20r
    s_cmp_eq_u32 s17, s40
    s_cbranch_scc1 P_20d
P_20r:
    s_add_u32 s41, s41, 16
    s_cmp_lt_u32 s41, 400000
    s_cbranch_scc1 P_20
P_20d:
    buffer_load_dwordx4 v[32:35], v29, s[44:47], s87 offen sc1
W_22:
    ds_read_b32 v2, v7
    s_waitcnt lgkmcnt(0)
    v_cmp_gt_i32 vcc, s67, v2
    s_cbranch_vccz W_22d
    s_add_u32 s41, s41, 1
    s_cmp_lt_u32 s41, 400000
    s_cbranch_scc1 W_22
W_22d:
    ds_read_b64_tr_b16 v[64:65], v150 offset:0
    ds_read_b64_tr_b16 v[66:67], v150 offset:4096
    ds_read_b64_tr_b16 v[68:69], v151 offset:0
    ds_read_b64_tr_b16 v[70:71], v151 offset:4096
    ds_read_b64_tr_b16 v[72:73], v150 offset:8192
    ds_read_b64_tr_b16 v[74:75], v150 offset:12288
    ds_read_b64_tr_b16 v[76:77], v151 offset:8192
    ds_read_b64_tr_b16 v[78:79], v151 offset:12288
    ds_read_b64_tr_b16 v[80:81], v150 offset:16384
    ds_read_b64_tr_b16 v[82:83], v150 offset:20480
    ds_read_b64_tr_b16 v[84:85], v151 offset:16384
    ds_read_b64_tr_b16 v[86:87], v151 offset:20480
    ds_read_b64_tr_b16 v[88:89], v150 offset:24576
    ds_read_b64_tr_b16 v[90:91], v150 offset:28672
    ds_read_b64_tr_b16 v[92:93], v151 offset:24576
    ds_read_b64_tr_b16 v[94:95], v151 offset:28672
G_21c:
    s_waitcnt vmcnt(0)
    v_xor_b32 v112, v33, v15
    v_bitop3_b32 v112, v112, v35, v15 bitop3:0xf6
    v_cmp_ne_u32 vcc, 0, v112
    s_cbranch_vccz G_21d
    s_add_u32 s41, s41, 16
    s_cmp_ge_u32 s41, 400000
    s_cbranch_scc1 G_21d
    s_mov_b64 exec, vcc
    buffer_load_dwordx4 v[32:35], v29, s[44:47], s87 offen sc1
    s_mov_b64 exec, -1
    s_branch G_21c
G_21d:
    v_mov_b32 v33, v34
    ds_write_b64 v154, v[32:33]
    v_mov_b32 v2, 7
    ds_write_b32 v9, v2
WR_23:
    ds_read_b32 v2, v8
    ds_read_b128 v[48:51], v152 offset:0
    ds_read_b128 v[52:55], v152 offset:64
    ds_read_b128 v[56:59], v152 offset:128
    ds_read_b128 v[60:63], v152 offset:192
    s_waitcnt lgkmcnt(4)
    v_cmp_gt_i32 vcc, 7, v2
    s_cbranch_vccz WR_23d
    s_add_u32 s41, s41, 1
    s_cmp_lt_u32 s41, 400000
    s_cbranch_scc1 WR_23
WR_23d:
    s_waitcnt lgkmcnt(3)
    v_mfma_f32_16x16x32_bf16 v[128:131], v[64:67], v[48:51], 0
    v_mfma_f32_16x16x32_bf16 v[132:135], v[68:71], v[48:51], 0
    s_waitcnt lgkmcnt(2)
    v_mfma_f32_16x16x32_bf16 v[128:131], v[72:75], v[52:55], v[128:131]
    v_mfma_f32_16x16x32_bf16 v[132:135], v[76:79], v[52:55], v[132:135]
    s_waitcnt lgkmcnt(1)
    v_mfma_f32_16x16x32_bf16 v[128:131], v[80:83], v[56:59], v[128:131]
    v_mfma_f32_16x16x32_bf16 v[132:135], v[84:87], v[56:59], v[132:135]
    s_waitcnt lgkmcnt(0)
    v_mfma_f32_16x16x32_bf16 v[128:131], v[88:91], v[60:63], v[128:131]
    v_mfma_f32_16x16x32_bf16 v[132:135], v[92:95], v[60:63], v[132:135]
    s_nop 7
    v_cndmask_b32 v16, v128, v132, s[50:51]
    v_cndmask_b32 v17, v129, v133, s[50:51]
    v_cndmask_b32 v18, v130, v134, s[50:51]
    v_cndmask_b32 v19, v131, v135, s[50:51]
    v_mul_f32 v16, v164, v16
    v_mul_f32 v17, v164, v17
    v_mul_f32 v18, v164, v18
    v_mul_f32 v19, v164, v19
    ds_write_b128 v147, v[16:19]
    v_mov_b32 v2, 8
    ds_write_b32 v9, v2
    v_xor_b32 v15, 0x80000000, v15
W_24:
    ds_read_b32 v2, v7
    s_waitcnt lgkmcnt(0)
    v_cmp_gt_i32 vcc, s66, v2
    s_cbranch_vccz W_24d
    s_add_u32 s41, s41, 1
    s_cmp_lt_u32 s41, 400000
    s_cbranch_scc1 W_24
W_24d:
    buffer_load_dwordx4 v[100:103], v144, s[44:47], s84 offen sc1
G_25c:
    s_waitcnt vmcnt(0)
    v_xor_b32 v104, v101, v15
    v_bitop3_b32 v104, v104, v103, v15 bitop3:0xf6
    v_cmp_ne_u32 vcc, 0, v104
    s_cbranch_vccz G_25d
    s_add_u32 s41, s41, 16
    s_cmp_ge_u32 s41, 400000
    s_cbranch_scc1 G_25d
    s_mov_b64 exec, vcc
    buffer_load_dwordx4 v[100:103], v144, s[44:47], s84 offen sc1
    s_mov_b64 exec, -1
    s_branch G_25c
G_25d:
    v_lshlrev_b32 v64, 16, v100
    v_and_b32 v65, 0xffff0000, v100
    v_lshlrev_b32 v66, 16, v102
    v_and_b32 v67, 0xffff0000, v102
    s_nop 0
    v_permlane32_swap_b32 v64, v66
    v_permlane32_swap_b32 v65, v67
    v_add_f32 v64, v64, v66
    v_add_f32 v65, v65, v67
    s_nop 1
    v_permlane16_swap_b32 v64, v65
    v_add_f32 v64, v64, v65
    s_nop 1
    v_add_f32_dpp v64, v64, v64 row_ror:8 row_mask:0xf bank_mask:0xf
    s_nop 1
    v_add_f32_dpp v64, v64, v64 row_ror:4 row_mask:0xf bank_mask:0xf
    s_nop 1
    v_add_f32_dpp v64, v64, v64 row_ror:2 row_mask:0xf bank_mask:0xf
    v_cvt_pk_bf16_f32 v64, v64, v64
    s_mov_b32 exec_lo, 0x00030003
    s_mov_b32 exec_hi, 0x00030003
    buffer_store_short v64, v145, s[88:91], s85 offen
    s_add_u32 s8, s2, s9
    s_cmp_lg_u32 s8, 0
    s_cbranch_scc1 L_Aend
    s_mov_b64 exec, 1
    buffer_store_dword v111, v29, s[44:47], 0 offen sc1
L_Aend:
    s_endpgm
L_B:
    v_lshrrev_b32 v2, 1, v6
    v_lshlrev_b32 v153, 18, v2
    v_and_b32 v2, 1, v6
    v_lshl_add_u32 v153, v2, 14, v153
    v_lshl_add_u32 v153, v5, 4, v153
    v_lshrrev_b32 v2, 3, v4
    v_lshl_add_u32 v153, v2, 6, v153
    s_lshl_b32 s66, s6, 3
    s_add_u32 s66, s66, s9
    s_lshl_b32 s66, s66, 5
    s_add_u32 s66, s66, s7
    s_lshl_b32 s66, s66, 7
    s_add_u32 s66, s66, 1572864
    v_lshlrev_b32 v26, 2, v3
    s_lshl_b32 s67, s6, 7
    s_add_u32 s67, s67, 12288
    v_lshlrev_b32 v25, 4, v3
    s_lshl_b32 s8, s9, 8
    v_add_u32 v146, s8, v7
    s_cmp_lg_u32 s9, 2
    s_cbranch_scc1 L_nodpre
W_26:
    ds_read_b32 v2, v7
    s_waitcnt lgkmcnt(0)
    v_cmp_gt_i32 vcc, 64, v2
    s_cbranch_vccz W_26d
    s_add_u32 s41, s41, 1
    s_cmp_lt_u32 s41, 400000
    s_cbranch_scc1 W_26
W_26d:
    s_lshl_b32 s8, s13, 12
    s_add_u32 s8, s8, s62
    v_lshlrev_b32 v2, 3, v25
    s_mov_b32 exec_hi, 0
    buffer_load_dword v160, v2, s[44:47], s8 offen
    s_lshl_b32 s8, s13, 6
    s_add_u32 s8, s8, s63
    s_mov_b64 exec, 1
    buffer_load_dword v160, v29, s[44:47], s8 offen
    s_mov_b64 exec, -1
L_nodpre:
    s_cmp_eq_u32 s13, 7
    s_cbranch_scc1 L_hub
    s_cmp_lg_u32 s9, 1
    s_cbranch_scc1 NM_27
W_28:
    ds_read_b32 v2, v7
    s_waitcnt lgkmcnt(0)
    v_cmp_gt_i32 vcc, 72, v2
    s_cbranch_vccz W_28d
    s_add_u32 s41, s41, 1
    s_cmp_lt_u32 s41, 400000
    s_cbranch_scc1 W_28
W_28d:
    s_lshl_b32 s8, s6, 9
    s_add_u32 s8, s8, 4096
    buffer_load_dword v160, v26, s[44:47], s67 offen
    buffer_load_dwordx4 v[96:99], v25, s[44:47], s8 offen sc1
G_29c:
    s_waitcnt vmcnt(0)
    v_xor_b32 v112, v97, v15
    v_bitop3_b32 v112, v112, v99, v15 bitop3:0xf6
    v_cmp_ne_u32 vcc, 0, v112
    s_cbranch_vccz G_29d
    s_add_u32 s41, s41, 16
    s_cmp_ge_u32 s41, 400000
    s_cbranch_scc1 G_29d
    s_mov_b64 exec, vcc
    buffer_load_dwordx4 v[96:99], v25, s[44:47], s8 offen sc1
    s_mov_b64 exec, -1
    s_branch G_29c
G_29d:
    v_lshlrev_b32 v100, 16, v98
    v_and_b32 v101, 0xffff0000, v98
    v_lshl_add_u32 v2, v1, 3, v7
    s_mov_b64 exec, 0xff
    ds_write_b64 v2, v[100:101] offset:2560
    s_mov_b64 exec, -1
    s_getreg_b32 s8, hwreg(HW_REG_XCC_ID, 0, 4)
    v_xor_b32 v3, s8, v96
    v_or_b32 v3, v3, v112
    v_cmp_ne_u32 vcc, 0, v3
    s_cmp_eq_u64 vcc, 0
    s_cselect_b32 s8, 2, 1
    v_mov_b32 v3, s8
    v_lshl_add_u32 v2, v1, 2, v7
    ds_write_b32 v2, v3 offset:2816
NM_27:
    s_lshl_b32 s52, s5, 2
    s_add_u32 s52, s52, s9
    s_lshl_b32 s52, s52, 7
    s_lshl_b32 s8, s4, 17
    s_add_u32 s52, s52, s8
    s_add_u32 s52, s52, 1048576
    v_lshrrev_b32 v2, 1, v6
    v_lshlrev_b32 v14, 15, v2
    v_and_b32 v2, 1, v6
    v_lshl_add_u32 v14, v2, 6, v14
    v_lshl_add_u32 v14, v5, 4, v14
    v_lshlrev_b32 v154, 6, v5
    v_lshl_add_u32 v154, v12, 1, v154
    v_and_b32 v2, 8, v1
    v_add_u32 v154, v154, v2
    v_bfe_u32 v2, v1, 2, 1
    v_mul_u32_u24 v2, 544, v2
    v_add_u32 v154, v154, v2
    s_mul_i32 s8, s9, 1088
    s_add_u32 s8, s8, 137728
    v_add_u32 v154, s8, v154
    v_add_u32 v13, 98304, v13
    s_lshr_b32 s60, s5, 1
    s_lshl_b32 s60, s60, 10
    s_and_b32 s8, s5, 1
    s_lshl_b32 s8, s8, 4
    s_add_u32 s60, s60, s8
    s_lshl_b32 s8, s4, 2
    s_add_u32 s60, s60, s8
    s_add_u32 s60, s60, 32768
    v_lshlrev_b32 v24, 7, v1
    s_sub_u32 s14, s7, s4
    s_lshl_b32 s8, s14, 3
    s_add_u32 s8, s8, s6
    s_lshl_b32 s8, s8, 7
    s_add_u32 s8, s8, 32768
    s_add_u32 s54, s38, s8
    s_addc_u32 s55, s39, 0
    v_mov_b32 v30, v29
    s_lshl_b32 s56, s14, 10
    s_lshl_b32 s8, s9, 15
    s_add_u32 s56, s56, s8
    s_add_u32 s56, s56, 1048576
    s_add_u32 s57, s56, 0x20000
    s_add_u32 s58, s56, 0x40000
    s_add_u32 s59, s56, 0x60000
    s_mov_b32 s42, s40
    s_mov_b32 s43, s40
W_30:
    ds_read_b32 v2, v166
    s_waitcnt lgkmcnt(0)
    v_cmp_gt_i32 vcc, 1, v2
    s_cbranch_vccz W_30d
    s_add_u32 s41, s41, 1
    s_cmp_lt_u32 s41, 400000
    s_cbranch_scc1 W_30
W_30d:
    ds_read_b64 v[32:33], v10 offset:0
    ds_read_b64 v[40:41], v10 offset:128
    ds_read_b64 v[48:49], v10 offset:256
    ds_read_b64 v[56:57], v10 offset:384
    v_xor_b32 v3, 32, v10
    ds_read_b64 v[34:35], v3 offset:0
    ds_read_b64 v[42:43], v3 offset:128
    ds_read_b64 v[50:51], v3 offset:256
    ds_read_b64 v[58:59], v3 offset:384
    v_xor_b32 v3, 64, v10
    ds_read_b64 v[36:37], v3 offset:0
    ds_read_b64 v[44:45], v3 offset:128
    ds_read_b64 v[52:53], v3 offset:256
    ds_read_b64 v[60:61], v3 offset:384
    v_xor_b32 v3, 96, v10
    ds_read_b64 v[38:39], v3 offset:0
    ds_read_b64 v[46:47], v3 offset:128
    ds_read_b64 v[54:55], v3 offset:256
    ds_read_b64 v[62:63], v3 offset:384
W_31:
    ds_read_b32 v2, v7 offset:2816
    s_waitcnt lgkmcnt(0)
    v_cmp_gt_i32 vcc, 1, v2
    s_cbranch_vccz W_31d
    s_add_u32 s41, s41, 1
    s_cmp_lt_u32 s41, 400000
    s_cbranch_scc1 W_31
W_31d:
    v_readfirstlane_b32 s53, v2
    v_lshl_add_u32 v3, v6, 3, v7
    ds_read_b64 v[164:165], v3 offset:2560
W_32:
    ds_read_b32 v2, v7
    s_waitcnt lgkmcnt(0)
    v_cmp_gt_i32 vcc, 120, v2
    s_cbranch_vccz W_32d
    s_add_u32 s41, s41, 1
    s_cmp_lt_u32 s41, 400000
    s_cbranch_scc1 W_32
W_32d:
    ds_read_b64_tr_b16 v[64:65], v13 offset:0
    ds_read_b64_tr_b16 v[66:67], v13 offset:2048
    ds_read_b64_tr_b16 v[68:69], v13 offset:4096
    ds_read_b64_tr_b16 v[70:71], v13 offset:6144
    ds_read_b64_tr_b16 v[72:73], v13 offset:8192
    ds_read_b64_tr_b16 v[74:75], v13 offset:10240
    ds_read_b64_tr_b16 v[76:77], v13 offset:12288
    ds_read_b64_tr_b16 v[78:79], v13 offset:14336
    ds_read_b64_tr_b16 v[80:81], v13 offset:16384
    ds_read_b64_tr_b16 v[82:83], v13 offset:18432
    ds_read_b64_tr_b16 v[84:85], v13 offset:20480
    ds_read_b64_tr_b16 v[86:87], v13 offset:22528
    s_waitcnt lgkmcnt(10)
    v_mfma_f32_16x16x32_bf16 v[16:19], v[64:67], v[32:35], 0
    s_waitcnt lgkmcnt(8)
    v_mfma_f32_16x16x32_bf16 v[16:19], v[68:71], v[36:39], v[16:19]
    s_waitcnt lgkmcnt(6)
    v_mfma_f32_16x16x32_bf16 v[16:19], v[72:75], v[40:43], v[16:19]
    s_waitcnt lgkmcnt(4)
    v_mfma_f32_16x16x32_bf16 v[16:19], v[76:79], v[44:47], v[16:19]
    s_waitcnt lgkmcnt(2)
    v_mfma_f32_16x16x32_bf16 v[16:19], v[80:83], v[48:51], v[16:19]
    s_waitcnt lgkmcnt(0)
    v_mfma_f32_16x16x32_bf16 v[16:19], v[84:87], v[52:55], v[16:19]
WR_33:
    ds_read_b32 v2, v7
    ds_read_b64_tr_b16 v[88:89], v13 offset:24576
    ds_read_b64_tr_b16 v[90:91], v13 offset:26624
    ds_read_b64_tr_b16 v[92:93], v13 offset:28672
    ds_read_b64_tr_b16 v[94:95], v13 offset:30720
    s_waitcnt lgkmcnt(4)
    v_cmp_gt_i32 vcc, 128, v2
    s_cbranch_vccz WR_33d
    s_add_u32 s41, s41, 1
    s_cmp_lt_u32 s41, 400000
    s_cbranch_scc1 WR_33
WR_33d:
    s_waitcnt lgkmcnt(2)
    v_mfma_f32_16x16x32_bf16 v[16:19], v[88:91], v[56:59], v[16:19]
    s_waitcnt lgkmcnt(0)
    v_mfma_f32_16x16x32_bf16 v[16:19], v[92:95], v[60:63], v[16:19]
    s_nop 7
    v_cvt_pk_bf16_f32 v20, v16, v17
    v_cvt_pk_bf16_f32 v22, v18, v19
    s_mov_b64 exec, s[48:49]
    buffer_store_dwordx4 v[20:23], v14, s[44:47], s52 offen sc1
    s_mov_b64 exec, -1
    v_mov_b32 v2, 2
    ds_write_b32 v9, v2
    s_cmp_lg_u32 s9, 0
    s_cbranch_scc1 L_Bw1d
W_34:
    ds_read_b32 v2, v8 offset:1024
    s_waitcnt lgkmcnt(0)
    v_cmp_gt_i32 vcc, 2, v2
    s_cbranch_vccz W_34d
    s_add_u32 s41, s41, 1
    s_cmp_lt_u32 s41, 400000
    s_cbranch_scc1 W_34
W_34d:
    s_mov_b64 exec, 0xff
    buffer_store_dword v15, v24, s[44:47], s60 offen sc1
    s_mov_b64 exec, -1
L_Bw1d:
P_35:
    s_load_dwordx8 s[84:91], s[54:55], 0 glc
    s_waitcnt lgkmcnt(0)
    s_cmp_eq_u64 s[84:85], s[42:43]
    s_cbranch_scc0 P_35r
    s_cmp_eq_u64 s[86:87], s[42:43]
    s_cbranch_scc0 P_35r
    s_cmp_eq_u64 s[88:89], s[42:43]
    s_cbranch_scc0 P_35r
    s_cmp_eq_u64 s[90:91], s[42:43]
    s_cbranch_scc0 P_35r
    s_branch P_35d
P_35r:
    s_add_u32 s41, s41, 16
    s_cmp_lt_u32 s41, 400000
    s_cbranch_scc1 P_35
P_35d:
    buffer_load_dwordx4 v[32:35], v30, s[44:47], s56 offen sc1
    buffer_load_dwordx4 v[36:39], v30, s[44:47], s57 offen sc1
    buffer_load_dwordx4 v[40:43], v30, s[44:47], s58 offen sc1
    buffer_load_dwordx4 v[44:47], v30, s[44:47], s59 offen sc1
G_36c:
    s_waitcnt vmcnt(0)
    v_xor_b32 v112, v33, v15
    v_bitop3_b32 v112, v112, v35, v15 bitop3:0xf6
    v_xor_b32 v113, v37, v15
    v_bitop3_b32 v113, v113, v39, v15 bitop3:0xf6
    v_xor_b32 v114, v41, v15
    v_bitop3_b32 v114, v114, v43, v15 bitop3:0xf6
    v_xor_b32 v115, v45, v15
    v_bitop3_b32 v115, v115, v47, v15 bitop3:0xf6
    v_or_b32 v2, v112, v113
    v_or3_b32 v2, v2, v114, v115
    v_cmp_ne_u32 vcc, 0, v2
    s_cbranch_vccz G_36d
    s_add_u32 s41, s41, 16
    s_cmp_ge_u32 s41, 400000
    s_cbranch_scc1 G_36d
    v_cmp_ne_u32 s[16:17], 0, v112
    v_cmp_ne_u32 s[18:19], 0, v113
    v_cmp_ne_u32 s[20:21], 0, v114
    v_cmp_ne_u32 s[22:23], 0, v115
    s_mov_b64 exec, s[16:17]
    s_cbranch_execz S_37
    buffer_load_dwordx4 v[32:35], v30, s[44:47], s56 offen sc1
S_37:
    s_mov_b64 exec, s[18:19]
    s_cbranch_execz S_38
    buffer_load_dwordx4 v[36:39], v30, s[44:47], s57 offen sc1
S_38:
    s_mov_b64 exec, s[20:21]
    s_cbranch_execz S_39
    buffer_load_dwordx4 v[40:43], v30, s[44:47], s58 offen sc1
S_39:
    s_mov_b64 exec, s[22:23]
    s_cbranch_execz S_40
    buffer_load_dwordx4 v[44:47], v30, s[44:47], s59 offen sc1
S_40:
    s_mov_b64 exec, -1
    s_branch G_36c
G_36d:
    v_lshlrev_b32 v16, 16, v32
    v_and_b32 v17, 0xffff0000, v32
    v_lshlrev_b32 v2, 16, v36
    v_and_b32 v3, 0xffff0000, v36
    v_add_f32 v16, v16, v2
    v_add_f32 v17, v17, v3
    v_lshlrev_b32 v2, 16, v40
    v_and_b32 v3, 0xffff0000, v40
    v_add_f32 v16, v16, v2
    v_add_f32 v17, v17, v3
    v_lshlrev_b32 v2, 16, v44
    v_and_b32 v3, 0xffff0000, v44
    v_add_f32 v16, v16, v2
    v_add_f32 v17, v17, v3
    v_lshlrev_b32 v18, 16, v34
    v_and_b32 v19, 0xffff0000, v34
    v_lshlrev_b32 v2, 16, v38
    v_and_b32 v3, 0xffff0000, v38
    v_add_f32 v18, v18, v2
    v_add_f32 v19, v19, v3
    v_lshlrev_b32 v2, 16, v42
    v_and_b32 v3, 0xffff0000, v42
    v_add_f32 v18, v18, v2
    v_add_f32 v19, v19, v3
    v_lshlrev_b32 v2, 16, v46
    v_and_b32 v3, 0xffff0000, v46
    v_add_f32 v18, v18, v2
    v_add_f32 v19, v19, v3
    v_max_f32 v16, 0, v16
    v_max_f32 v17, 0, v17
    v_max_f32 v18, 0, v18
    v_max_f32 v19, 0, v19
    v_cvt_pk_bf16_f32 v20, v16, v17
    v_cvt_pk_bf16_f32 v21, v18, v19
    ds_write_b64 v154, v[20:21] offset:256
    v_mov_b32 v2, 3
    ds_write_b32 v9, v2
    v_xor_b32 v157, 0x80000000, v15
    v_mov_b32 v159, v157
    buffer_load_dword v27, v26, s[44:47], s67 offen sc1
    ds_read_b32 v2, v7
    s_waitcnt lgkmcnt(0)
    v_readfirstlane_b32 s15, v2
    s_cmp_lt_i32 s15, 184
    s_cbranch_scc1 L_w2no
    ds_read_b64_tr_b16 v[64:65], v150 offset:32768
    ds_read_b64_tr_b16 v[66:67], v150 offset:36864
    ds_read_b64_tr_b16 v[68:69], v151 offset:32768
    ds_read_b64_tr_b16 v[70:71], v151 offset:36864
    ds_read_b64_tr_b16 v[72:73], v150 offset:40960
    ds_read_b64_tr_b16 v[74:75], v150 offset:45056
    ds_read_b64_tr_b16 v[76:77], v151 offset:40960
    ds_read_b64_tr_b16 v[78:79], v151 offset:45056
    ds_read_b64_tr_b16 v[80:81], v150 offset:49152
    ds_read_b64_tr_b16 v[82:83], v150 offset:53248
    ds_read_b64_tr_b16 v[84:85], v151 offset:49152
    ds_read_b64_tr_b16 v[86:87], v151 offset:53248
L_w2no:
WR_42:
    ds_read_b32 v2, v8 offset:1024
    ds_read_b128 v[48:51], v152 offset:256
    ds_read_b128 v[52:55], v152 offset:320
    ds_read_b128 v[56:59], v152 offset:384
    ds_read_b128 v[60:63], v152 offset:448
    s_waitcnt lgkmcnt(4)
    v_cmp_gt_i32 vcc, 3, v2
    s_cbranch_vccz WR_42d
    s_add_u32 s41, s41, 1
    s_cmp_lt_u32 s41, 400000
    s_cbranch_scc1 WR_42
WR_42d:
    s_cmp_ge_i32 s15, 184
    s_cbranch_scc1 L_w2have
W_43:
    ds_read_b32 v2, v7
    s_waitcnt lgkmcnt(0)
    v_cmp_gt_i32 vcc, 184, v2
    s_cbranch_vccz W_43d
    s_add_u32 s41, s41, 1
    s_cmp_lt_u32 s41, 400000
    s_cbranch_scc1 W_43
W_43d:
    ds_read_b64_tr_b16 v[64:65], v150 offset:32768
    ds_read_b64_tr_b16 v[66:67], v150 offset:36864
    ds_read_b64_tr_b16 v[68:69], v151 offset:32768
    ds_read_b64_tr_b16 v[70:71], v151 offset:36864
    ds_read_b64_tr_b16 v[72:73], v150 offset:40960
    ds_read_b64_tr_b16 v[74:75], v150 offset:45056
    ds_read_b64_tr_b16 v[76:77], v151 offset:40960
    ds_read_b64_tr_b16 v[78:79], v151 offset:45056
    ds_read_b64_tr_b16 v[80:81], v150 offset:49152
    ds_read_b64_tr_b16 v[82:83], v150 offset:53248
    ds_read_b64_tr_b16 v[84:85], v151 offset:49152
    ds_read_b64_tr_b16 v[86:87], v151 offset:53248
L_w2have:
    s_waitcnt lgkmcnt(0)
    v_mfma_f32_16x16x32_bf16 v[128:131], v[64:67], v[48:51], 0
    v_mfma_f32_16x16x32_bf16 v[132:135], v[68:71], v[48:51], 0
    v_mfma_f32_16x16x32_bf16 v[128:131], v[72:75], v[52:55], v[128:131]
    v_mfma_f32_16x16x32_bf16 v[132:135], v[76:79], v[52:55], v[132:135]
    v_mfma_f32_16x16x32_bf16 v[128:131], v[80:83], v[56:59], v[128:131]
    v_mfma_f32_16x16x32_bf16 v[132:135], v[84:87], v[56:59], v[132:135]
WR_44:
    ds_read_b32 v2, v7
    ds_read_b64_tr_b16 v[88:89], v150 offset:57344
    ds_read_b64_tr_b16 v[90:91], v150 offset:61440
    ds_read_b64_tr_b16 v[92:93], v151 offset:57344
    ds_read_b64_tr_b16 v[94:95], v151 offset:61440
    s_waitcnt lgkmcnt(4)
    v_cmp_gt_i32 vcc, 192, v2
    s_cbranch_vccz WR_44d
    s_add_u32 s41, s41, 1
    s_cmp_lt_u32 s41, 400000
    s_cbranch_scc1 WR_44
WR_44d:
    ds_read_b32 v3, v146 offset:256
    ds_read_b128 v[96:99], v147
    s_waitcnt lgkmcnt(2)
    v_mfma_f32_16x16x32_bf16 v[128:131], v[88:91], v[60:63], v[128:131]
    v_mfma_f32_16x16x32_bf16 v[132:135], v[92:95], v[60:63], v[132:135]
    s_waitcnt lgkmcnt(0)
    v_cmp_gt_i32 vcc, 8, v3
    s_nop 5
    v_cndmask_b32 v16, v128, v132, s[50:51]
    v_cndmask_b32 v17, v129, v133, s[50:51]
    v_cndmask_b32 v18, v130, v134, s[50:51]
    v_cndmask_b32 v19, v131, v135, s[50:51]
    s_cbranch_vccz L_tok
L_tw:
    ds_read_b32 v3, v146 offset:256
    ds_read_b128 v[96:99], v147
    s_waitcnt lgkmcnt(0)
    v_cmp_gt_i32 vcc, 8, v3
    s_cbranch_vccz L_tok
    s_add_u32 s41, s41, 1
    s_cmp_lt_u32 s41, 400000
    s_cbranch_scc1 L_tw
L_tok:
    v_fmac_f32 v96, v165, v16
    v_fmac_f32 v97, v165, v17
    v_fmac_f32 v98, v165, v18
    v_fmac_f32 v99, v165, v19
    v_cvt_pk_bf16_f32 v156, v96, v97
    v_cvt_pk_bf16_f32 v158, v98, v99
G_41c:
    s_waitcnt vmcnt(0)
    v_xor_b32 v140, v27, v15
    v_cmp_ne_u32 vcc, 0, v140
    s_cbranch_vccz G_41d
    s_add_u32 s41, s41, 16
    s_cmp_ge_u32 s41, 400000
    s_cbranch_scc1 G_41d
    s_mov_b64 exec, vcc
    buffer_load_dword v27, v26, s[44:47], s67 offen sc1
    s_mov_b64 exec, -1
    s_branch G_41c
G_41d:
    s_cmp_eq_u32 s53, 2
    s_cbranch_scc0 F_45
    buffer_store_dwordx4 v[156:159], v153, s[44:47], s66 offen
    s_branch F_45e
F_45:
    buffer_store_dwordx4 v[156:159], v153, s[44:47], s66 offen sc1
F_45e:
    s_endpgm
L_comb:
    s_lshl_b32 s8, s86, 12
    s_add_u32 s56, s62, s8
    s_lshl_b32 s8, s86, 6
    s_add_u32 s58, s63, s8
    v_and_b32 v31, 32, v1
    buffer_load_dwordx4 v[80:83], v31, s[44:47], s58 offen sc1
    buffer_load_dwordx4 v[84:87], v31, s[44:47], s58 offen offset:16 sc1
    buffer_load_dwordx4 v[32:35], v29, s[44:47], s56 offen sc1
    buffer_load_dwordx4 v[36:39], v29, s[44:47], s56 offen offset:1024 sc1
    buffer_load_dwordx4 v[40:43], v29, s[44:47], s56 offen offset:2048 sc1
    buffer_load_dwordx4 v[44:47], v29, s[44:47], s56 offen offset:3072 sc1
    s_lshl_b32 s59, s12, 3
    s_add_u32 s59, s59, s86
    s_lshl_b32 s59, s59, 3
    s_add_u32 s59, s59, s11
    s_lshl_b32 s59, s59, 9
    s_add_u32 s59, s59, 262144
    v_and_b32 v2, 31, v1
    v_lshrrev_b32 v30, 2, v31
    v_lshl_add_u32 v30, v2, 4, v30
    s_lshl_b32 s60, s6, 2
    s_add_u32 s60, s60, s4
    s_lshl_b32 s60, s60, 3
    s_add_u32 s60, s60, s86
    s_lshl_b32 s60, s60, 2
    s_add_u32 s60, s60, 12288
    v_mov_b32 v101, v15
G_46c:
    s_waitcnt vmcnt(0)
    v_xor_b32 v112, v81, v15
    v_bitop3_b32 v112, v112, v83, v15 bitop3:0xf6
    v_xor_b32 v113, v85, v15
    v_bitop3_b32 v113, v113, v87, v15 bitop3:0xf6
    v_xor_b32 v114, v33, v15
    v_bitop3_b32 v114, v114, v35, v15 bitop3:0xf6
    v_xor_b32 v115, v37, v15
    v_bitop3_b32 v115, v115, v39, v15 bitop3:0xf6
    v_xor_b32 v116, v41, v15
    v_bitop3_b32 v116, v116, v43, v15 bitop3:0xf6
    v_xor_b32 v117, v45, v15
    v_bitop3_b32 v117, v117, v47, v15 bitop3:0xf6
    v_or_b32 v2, v112, v113
    v_or3_b32 v2, v2, v114, v115
    v_or3_b32 v2, v2, v116, v117
    v_cmp_ne_u32 vcc, 0, v2
    s_cbranch_vccz G_46d
    s_add_u32 s41, s41, 16
    s_cmp_ge_u32 s41, 400000
    s_cbranch_scc1 G_46d
    v_cmp_ne_u32 s[16:17], 0, v112
    v_cmp_ne_u32 s[18:19], 0, v113
    v_cmp_ne_u32 s[20:21], 0, v114
    v_cmp_ne_u32 s[22:23], 0, v115
    v_cmp_ne_u32 s[24:25], 0, v116
    v_cmp_ne_u32 s[26:27], 0, v117
    s_mov_b64 exec, s[16:17]
    s_cbranch_execz S_47
    buffer_load_dwordx4 v[80:83], v31, s[44:47], s58 offen sc1
S_47:
    s_mov_b64 exec, s[18:19]
    s_cbranch_execz S_48
    buffer_load_dwordx4 v[84:87], v31, s[44:47], s58 offen offset:16 sc1
S_48:
    s_mov_b64 exec, s[20:21]
    s_cbranch_execz S_49
    buffer_load_dwordx4 v[32:35], v29, s[44:47], s56 offen sc1
S_49:
    s_mov_b64 exec, s[22:23]
    s_cbranch_execz S_50
    buffer_load_dwordx4 v[36:39], v29, s[44:47], s56 offen offset:1024 sc1
S_50:
    s_mov_b64 exec, s[24:25]
    s_cbranch_execz S_51
    buffer_load_dwordx4 v[40:43], v29, s[44:47], s56 offen offset:2048 sc1
S_51:
    s_mov_b64 exec, s[26:27]
    s_cbranch_execz S_52
    buffer_load_dwordx4 v[44:47], v29, s[44:47], s56 offen offset:3072 sc1
S_52:
    s_mov_b64 exec, -1
    s_branch G_46c
G_46d:
    v_max3_f32 v16, v80, v82, v84
    v_max_f32 v16, v16, v86
    v_mov_b32 v17, v16
    v_lshlrev_b32 v48, 16, v32
    v_lshlrev_b32 v52, 16, v36
    v_lshlrev_b32 v56, 16, v40
    v_lshlrev_b32 v60, 16, v44
    v_permlane32_swap_b32 v16, v17
    v_max_f32 v16, v16, v17
    v_sub_f32 v80, v80, v16
    v_sub_f32 v82, v82, v16
    v_sub_f32 v84, v84, v16
    v_sub_f32 v86, v86, v16
    v_exp_f32 v80, v80
    v_exp_f32 v82, v82
    v_exp_f32 v84, v84
    v_exp_f32 v86, v86
    v_and_b32 v49, 0xffff0000, v32
    v_lshlrev_b32 v50, 16, v34
    v_and_b32 v51, 0xffff0000, v34
    v_and_b32 v53, 0xffff0000, v36
    v_lshlrev_b32 v54, 16, v38
    v_and_b32 v55, 0xffff0000, v38
    v_and_b32 v57, 0xffff0000, v40
    v_lshlrev_b32 v58, 16, v42
    v_and_b32 v59, 0xffff0000, v42
    v_and_b32 v61, 0xffff0000, v44
    v_lshlrev_b32 v62, 16, v46
    v_and_b32 v63, 0xffff0000, v46
    v_add_f32 v16, v80, v82
    v_add_f32 v17, v84, v86
    v_add_f32 v16, v16, v17
    v_mov_b32 v17, v16
    v_mul_f32 v96, v80, v48
    v_mul_f32 v97, v80, v49
    v_mul_f32 v98, v80, v50
    v_mul_f32 v99, v80, v51
    v_permlane32_swap_b32 v16, v17
    v_add_f32 v16, v16, v17
    v_rcp_f32 v16, v16
    v_fmac_f32 v96, v82, v52
    v_fmac_f32 v97, v82, v53
    v_fmac_f32 v98, v82, v54
    v_fmac_f32 v99, v82, v55
    v_fmac_f32 v96, v84, v56
    v_fmac_f32 v97, v84, v57
    v_fmac_f32 v98, v84, v58
    v_fmac_f32 v99, v84, v59
    v_fmac_f32 v96, v86, v60
    v_fmac_f32 v97, v86, v61
    v_fmac_f32 v98, v86, v62
    v_fmac_f32 v99, v86, v63
    s_nop 0
    v_permlane32_swap_b32 v96, v98
    v_permlane32_swap_b32 v97, v99
    v_add_f32 v96, v96, v98
    v_add_f32 v97, v97, v99
    v_mul_f32 v96, v96, v16
    v_mul_f32 v97, v97, v16
    v_cvt_pk_bf16_f32 v100, v96, v97
    buffer_store_dwordx2 v[100:101], v30, s[44:47], s59 offen sc1
    s_cmp_eq_u32 s53, 2
    s_cbranch_scc0 F_53
    s_mov_b64 exec, 1
    buffer_store_dword v15, v29, s[44:47], s60 offen
    s_branch F_53e
F_53:
    s_mov_b64 exec, 1
    buffer_store_dword v15, v29, s[44:47], s60 offen sc1
F_53e:
    s_mov_b64 exec, -1
    s_setpc_b64 s[94:95]
L_hub:
    s_cmp_lg_u32 s9, 1
    s_cbranch_scc1 NM_54
W_55:
    ds_read_b32 v2, v7
    s_waitcnt lgkmcnt(0)
    v_cmp_gt_i32 vcc, 72, v2
    s_cbranch_vccz W_55d
    s_add_u32 s41, s41, 1
    s_cmp_lt_u32 s41, 400000
    s_cbranch_scc1 W_55
W_55d:
    s_lshl_b32 s8, s6, 9
    s_add_u32 s8, s8, 4096
    buffer_load_dword v160, v26, s[44:47], s67 offen
    buffer_load_dwordx4 v[96:99], v25, s[44:47], s8 offen sc1
G_56c:
    s_waitcnt vmcnt(0)
    v_xor_b32 v112, v97, v15
    v_bitop3_b32 v112, v112, v99, v15 bitop3:0xf6
    v_cmp_ne_u32 vcc, 0, v112
    s_cbranch_vccz G_56d
    s_add_u32 s41, s41, 16
    s_cmp_ge_u32 s41, 400000
    s_cbranch_scc1 G_56d
    s_mov_b64 exec, vcc
    buffer_load_dwordx4 v[96:99], v25, s[44:47], s8 offen sc1
    s_mov_b64 exec, -1
    s_branch G_56c
G_56d:
    v_lshlrev_b32 v100, 16, v98
    v_and_b32 v101, 0xffff0000, v98
    v_lshl_add_u32 v2, v1, 3, v7
    s_mov_b64 exec, 0xff
    ds_write_b64 v2, v[100:101] offset:2560
    s_mov_b64 exec, -1
    s_getreg_b32 s8, hwreg(HW_REG_XCC_ID, 0, 4)
    v_xor_b32 v3, s8, v96
    v_or_b32 v3, v3, v112
    v_cmp_ne_u32 vcc, 0, v3
    s_cmp_eq_u64 vcc, 0
    s_cselect_b32 s8, 2, 1
    v_mov_b32 v3, s8
    v_lshl_add_u32 v2, v1, 2, v7
    ds_write_b32 v2, v3 offset:2816
NM_54:
W_57:
    ds_read_b32 v2, v7 offset:2816
    s_waitcnt lgkmcnt(0)
    v_cmp_gt_i32 vcc, 1, v2
    s_cbranch_vccz W_57d
    s_add_u32 s41, s41, 1
    s_cmp_lt_u32 s41, 400000
    s_cbranch_scc1 W_57
W_57d:
    v_readfirstlane_b32 s53, v2
    v_lshl_add_u32 v3, v6, 3, v7
    ds_read_b64 v[164:165], v3 offset:2560
W_58:
    ds_read_b32 v2, v8
    s_waitcnt lgkmcnt(0)
    v_cmp_gt_i32 vcc, 6, v2
    s_cbranch_vccz W_58d
    s_add_u32 s41, s41, 1
    s_cmp_lt_u32 s41, 400000
    s_cbranch_scc1 W_58
W_58d:
    s_add_u32 s86, s9, 4
    s_call_b64 s[94:95], L_comb
W_59:
    ds_read_b32 v2, v146 offset:256
    s_waitcnt lgkmcnt(0)
    v_cmp_gt_i32 vcc, 8, v2
    s_cbranch_vccz W_59d
    s_add_u32 s41, s41, 1
    s_cmp_lt_u32 s41, 400000
    s_cbranch_scc1 W_59
W_59d:
    v_xor_b32 v157, 0x80000000, v15
    v_mov_b32 v159, v157
    buffer_load_dword v27, v26, s[44:47], s67 offen sc1
    ds_read_b128 v[96:99], v147
    s_waitcnt lgkmcnt(0)
    v_cvt_pk_bf16_f32 v156, v96, v97
    v_cvt_pk_bf16_f32 v158, v98, v99
G_60c:
    s_waitcnt vmcnt(0)
    v_xor_b32 v140, v27, v15
    v_cmp_ne_u32 vcc, 0, v140
    s_cbranch_vccz G_60d
    s_add_u32 s41, s41, 16
    s_cmp_ge_u32 s41, 400000
    s_cbranch_scc1 G_60d
    s_mov_b64 exec, vcc
    buffer_load_dword v27, v26, s[44:47], s67 offen sc1
    s_mov_b64 exec, -1
    s_branch G_60c
G_60d:
    s_cmp_eq_u32 s53, 2
    s_cbranch_scc0 F_61
    buffer_store_dwordx4 v[156:159], v153, s[44:47], s66 offen
    s_branch F_61e
F_61:
    buffer_store_dwordx4 v[156:159], v153, s[44:47], s66 offen sc1
F_61e:
    s_endpgm
L_codeend:
.section .rodata,"a"
.p2align 6
.amdhsa_kernel gated_mix__sliding_block_cached__dense_activation_relu__decode_kernel
  .amdhsa_next_free_vgpr 168
  .amdhsa_next_free_sgpr 102
  .amdhsa_accum_offset 168
  .amdhsa_group_segment_fixed_size 0
  .amdhsa_kernarg_size 96
  .amdhsa_user_sgpr_count 2
  .amdhsa_user_sgpr_kernarg_segment_ptr 1
  .amdhsa_system_sgpr_workgroup_id_x 1
  .amdhsa_float_denorm_mode_32 3
.end_amdhsa_kernel
```
